```python
import torch

def _softmax(x, axis=-1):
    return torch.softmax(x, dim=axis)
def _gelu(x):
    return torch.nn.functional.gelu(x, approximate="tanh")
def _silu(x):
    return torch.nn.functional.silu(x)
def _sigmoid(x):
    return torch.sigmoid(x)
def _layernorm(x, axis=-1, eps=1e-5):
    m = x.mean(dim=axis, keepdim=True)
    v = x.var(dim=axis, keepdim=True, unbiased=False)
    return (x - m) / torch.sqrt(v + eps)
def _scatter_add(tgt, idx, src, axis=0):
    return tgt.clone().index_add_(axis, idx, src)
def _segment_sum(src, seg, n):
    out = torch.zeros((n,) + src.shape[1:], dtype=src.dtype)
    return out.index_add_(0, seg, src)
def _pad(x, pw):
    flat = tuple(v for pair in reversed(pw) for v in pair)
    return torch.nn.functional.pad(x, flat)

kernel_name = 'sequential_preLN__sliding_block_cached__swiglu_ffn__decode'

def setup_inputs():

    _w = (lambda a: (lambda t: t.to(torch.bfloat16) if t.is_floating_point() else t)(torch.as_tensor(a)))
    def _A_setup():
        B, Sq, D = 2, 1, 512
        Hq, Hkv, Sk, Dh = 32, 8, 32768, 128
        assert Hq % Hkv == 0, (Hq, Hkv)
        return {
            "x": _w((lambda *s: torch.randn(*s, dtype=torch.bfloat16) * 0.05)(B, Sq, D)),
            "k_cache": _w((lambda *s: torch.randn(*s, dtype=torch.bfloat16) * 3.2)(B, Hkv, Sk, Dh)),
            "v_cache": _w((lambda *s: torch.randn(*s, dtype=torch.bfloat16) * 0.4)(B, Hkv, Sk, Dh)),
            "wq": _w((lambda *s: torch.randn(*s, dtype=torch.bfloat16) * 3.2)(D, Hq * Dh) * (D ** -0.5)),
            "wo": _w((lambda *s: torch.randn(*s, dtype=torch.bfloat16) * 0.4)(Hq * Dh, D) * ((Hq * Dh) ** -0.5)),
        }
    _A_in = _A_setup()

    def _B_setup():
        B, S, D, F = 2, 1, 512, 1792
        return {
            "x": _w((lambda *s: torch.randn(*s, dtype=torch.bfloat16) * 0.05)(B, S, D)),
            "w_gate": _w((lambda *s: torch.randn(*s, dtype=torch.bfloat16) * 0.05)(D, F)),
            "w_up": _w((lambda *s: torch.randn(*s, dtype=torch.bfloat16) * 0.05)(D, F)),
            "w_down": _w((lambda *s: torch.randn(*s, dtype=torch.bfloat16) * 0.05)(F, D)),
        }
    _B_in = _B_setup()

    return {
        "A_x": _A_in["x"],
        "A_k_cache": _A_in["k_cache"],
        "A_v_cache": _A_in["v_cache"],
        "A_wq": _A_in["wq"],
        "A_wo": _A_in["wo"],
        "B_x": _B_in["x"],
        "B_w_gate": _B_in["w_gate"],
        "B_w_up": _B_in["w_up"],
        "B_w_down": _B_in["w_down"],
    }

def reference(A_x, A_k_cache, A_v_cache, A_wq, A_wo, B_x, B_w_gate, B_w_up, B_w_down):
    def _A_ref(x, k_cache, v_cache, wq, wo):
        B, Sq, D = x.shape
        Hq, Dh = 32, 128
        Hkv, Sk = k_cache.shape[1], k_cache.shape[2]
        W = min(4096, max(256, Sk // 4))
        rep = Hq // Hkv
        q = (lambda x, *d: x.permute(*d))((x @ wq).reshape(B, Sq, Hq, Dh), 0, 2, 1, 3)
        k = (lambda x, n, axis: torch.repeat_interleave(x, n, dim=axis))(k_cache[:, :, Sk - W:, :], rep, axis=1)
        v = (lambda x, n, axis: torch.repeat_interleave(x, n, dim=axis))(v_cache[:, :, Sk - W:, :], rep, axis=1)
        scores = torch.einsum("bhqd,bhkd->bhqk", q, k) * (Dh ** -0.5)
        p = _softmax(scores, axis=-1)
        o = torch.einsum("bhqk,bhkd->bhqd", p, v)
        return (lambda x, *d: x.permute(*d))(o, 0, 2, 1, 3).reshape(B, Sq, Hq * Dh) @ wo

    def _B_ref(x, w_gate, w_up, w_down):
        g = _silu(x @ w_gate)
        u = x @ w_up
        return (g * u) @ w_down

    x = A_x
    h = x + _A_ref(_layernorm(x, axis=-1), A_k_cache, A_v_cache, A_wq, A_wo)
    h2 = h + _B_ref(_layernorm(h, axis=-1), B_w_gate, B_w_up, B_w_down)
    return h2
```

```asm
; @launch grid=(256,1,1) block=(256,1,1) lds=90112
.amdgcn_target "amdgcn-amd-amdhsa--gfx950"
.text
.globl sequential_preLN__sliding_block_cached__swiglu_ffn__decode_kernel
.p2align 8
.type sequential_preLN__sliding_block_cached__swiglu_ffn__decode_kernel,@function
sequential_preLN__sliding_block_cached__swiglu_ffn__decode_kernel:
    s_cmp_ge_u32 s2, 0x100
    s_cbranch_scc1 Lexit
    s_load_dwordx8 s[4:11], s[0:1], 0
    s_load_dwordx4 s[24:27], s[0:1], 80
    s_load_dwordx2 s[12:13], s[0:1], 32
    s_load_dwordx8 s[16:23], s[0:1], 48
    s_getpc_b64 s[62:63]
Lpc:
    v_and_b32 v1, 63, v0
    v_lshrrev_b32 v4, 6, v0
    v_and_b32 v2, 15, v1
    v_lshrrev_b32 v3, 4, v1
    v_readfirstlane_b32 s32, v4
    s_and_b32 s28, s2, 7
    s_lshr_b32 s29, s2, 3
    s_lshr_b32 s30, s29, 4
    s_and_b32 s31, s29, 15
    s_getreg_b32 s67, hwreg(HW_REG_XCC_ID)
    s_and_b32 s67, s67, 15
    s_lshl_b32 s34, s30, 3
    s_add_u32 s34, s34, s28
    s_lshl_b32 s34, s34, 15
    s_add_u32 s34, s34, 28672
    s_lshl_b32 s34, s34, 8
    s_lshl_b32 s33, s31, 16
    s_add_u32 s34, s34, s33
    s_lshl_b32 s33, s32, 10
    s_add_u32 s34, s34, s33
    s_lshl_b32 s35, s28, 1
    s_add_u32 s35, s35, s31
    s_and_b32 s35, s35, 15
    s_lshl_b32 s35, s35, 12
    s_lshr_b32 s33, s29, 3
    s_lshl_b32 s33, s33, 2
    s_add_u32 s33, s33, s32
    s_lshl_b32 s68, s33, 18
    s_lshl_b32 s33, s28, 10
    s_add_u32 s68, s68, s33
    s_and_b32 s33, s29, 7
    s_lshl_b32 s33, s33, 7
    s_add_u32 s68, s68, s33
    v_lshlrev_b32 v20, 4, v1
    s_and_b32 s33, s32, 1
    s_lshl_b32 s33, s33, 10
    v_add_u32 v5, s33, v20
    v_lshrrev_b32 v21, 3, v1
    v_lshlrev_b32 v21, 13, v21
    v_and_b32 v6, 7, v1
    v_lshlrev_b32 v6, 4, v6
    v_add_u32 v21, v21, v6
    s_lshl_b32 s33, s29, 2
    s_add_u32 s33, s33, s32
    s_and_b32 s33, s33, 15
    s_lshl_b32 s33, s33, 10
    v_add_u32 v7, s33, v20
    v_min_u32 v7, (Lcode_end-Lpc-16), v7
    v_mov_b32 v8, 0
    v_lshlrev_b32 v9, 2, v3
    v_lshlrev_b32 v10, 8, v3
    v_add_u32 v11, 0, v9
    v_xor_b32 v11, v11, v2
    v_lshl_add_u32 v16, v11, 4, v10
    v_add_u32 v11, 1, v9
    v_xor_b32 v11, v11, v2
    v_lshl_add_u32 v17, v11, 4, v10
    v_add_u32 v11, 2, v9
    v_xor_b32 v11, v11, v2
    v_lshl_add_u32 v18, v11, 4, v10
    v_add_u32 v11, 3, v9
    v_xor_b32 v11, v11, v2
    v_lshl_add_u32 v19, v11, 4, v10
    v_mov_b32 v23, 0xff
    v_mov_b32 v22, 0x1ff
    s_mov_b32 s65, 0x05040100
    s_mov_b32 s66, 0x07060302
    s_lshl_b32 s69, s32, 12
    s_add_u32 s69, s69, 8192
    s_lshl_b32 s33, s32, 14
    s_add_u32 s14, s33, 24576
    s_waitcnt lgkmcnt(0)
    global_load_dword v28, v8, s[26:27] sc1
    global_load_dwordx4 v[24:27], v5, s[4:5]
    s_add_u32 s52, s10, s68
    s_addc_u32 s53, s11, 0
    s_and_b32 s53, s53, 0xffff
    s_mov_b32 s54, 0x100000
    s_mov_b32 s55, 0x20000
    s_add_u32 m0, s69, 0
    s_mov_b32 s33, 0
    buffer_load_dwordx4 v21, s[52:55], s33 offen nt lds
    s_add_u32 m0, s69, 1024
    s_mov_b32 s33, 65536
    buffer_load_dwordx4 v21, s[52:55], s33 offen nt lds
    s_add_u32 m0, s69, 2048
    s_mov_b32 s33, 131072
    buffer_load_dwordx4 v21, s[52:55], s33 offen nt lds
    s_add_u32 m0, s69, 3072
    s_mov_b32 s33, 196608
    buffer_load_dwordx4 v21, s[52:55], s33 offen nt lds
    global_load_dwordx4 v[248:251], v7, s[62:63]
    s_add_u32 s44, s6, s34
    s_addc_u32 s45, s7, 0
    s_and_b32 s45, s45, 0xffff
    s_mov_b32 s46, 0x10000
    s_mov_b32 s47, 0x20000
    s_add_u32 s48, s8, s34
    s_addc_u32 s49, s9, 0
    s_and_b32 s49, s49, 0xffff
    s_mov_b32 s50, 0x10000
    s_mov_b32 s51, 0x20000
    s_waitcnt vmcnt(5)
    s_add_u32 s33, s35, 0
    s_and_b32 s33, s33, 0xffff
    s_add_u32 m0, s14, 0
    s_nop 0
    buffer_load_dwordx4 v16, s[44:47], s33 offen nt lds
    s_add_u32 s33, s35, 4096
    s_and_b32 s33, s33, 0xffff
    s_add_u32 m0, s14, 1024
    s_nop 0
    buffer_load_dwordx4 v17, s[44:47], s33 offen nt lds
    s_add_u32 s33, s35, 8192
    s_and_b32 s33, s33, 0xffff
    s_add_u32 m0, s14, 2048
    s_nop 0
    buffer_load_dwordx4 v18, s[44:47], s33 offen nt lds
    s_add_u32 s33, s35, 12288
    s_and_b32 s33, s33, 0xffff
    s_add_u32 m0, s14, 3072
    s_nop 0
    buffer_load_dwordx4 v19, s[44:47], s33 offen nt lds
    s_add_u32 s33, s35, 16384
    s_and_b32 s33, s33, 0xffff
    s_add_u32 m0, s14, 4096
    s_nop 0
    buffer_load_dwordx4 v16, s[44:47], s33 offen nt lds
    s_add_u32 s33, s35, 20480
    s_and_b32 s33, s33, 0xffff
    s_add_u32 m0, s14, 5120
    s_nop 0
    buffer_load_dwordx4 v17, s[44:47], s33 offen nt lds
    s_add_u32 s33, s35, 24576
    s_and_b32 s33, s33, 0xffff
    s_add_u32 m0, s14, 6144
    s_nop 0
    buffer_load_dwordx4 v18, s[44:47], s33 offen nt lds
    s_add_u32 s33, s35, 28672
    s_and_b32 s33, s33, 0xffff
    s_add_u32 m0, s14, 7168
    s_nop 0
    buffer_load_dwordx4 v19, s[44:47], s33 offen nt lds
    v_readfirstlane_b32 s60, v28
    s_nop 1
    s_add_u32 s60, s60, 1
    s_mul_i32 s33, s60, 0x01010101
    s_and_b32 s36, s33, 0xff
    s_bfe_u32 s37, s33, 0x80008
    s_bfe_u32 s38, s33, 0x80010
    s_lshr_b32 s39, s33, 24
    s_bfe_u32 s33, s67, 65536
    s_lshl_b32 s33, s33, 8
    s_or_b32 s40, s36, s33
    s_bfe_u32 s33, s67, 65537
    s_lshl_b32 s33, s33, 8
    s_or_b32 s41, s37, s33
    s_bfe_u32 s33, s67, 65538
    s_lshl_b32 s33, s33, 8
    s_or_b32 s42, s38, s33
    s_bfe_u32 s33, s67, 65539
    s_lshl_b32 s33, s33, 8
    s_or_b32 s43, s39, s33
    v_lshlrev_b32 v32, 16, v24
    v_and_b32 v33, 0xffff0000, v24
    v_lshlrev_b32 v34, 16, v25
    v_and_b32 v35, 0xffff0000, v25
    v_lshlrev_b32 v36, 16, v26
    v_and_b32 v37, 0xffff0000, v26
    v_lshlrev_b32 v38, 16, v27
    v_and_b32 v39, 0xffff0000, v27
    v_add_f32 v40, v32, v33
    v_add_f32 v41, v34, v35
    v_add_f32 v42, v36, v37
    v_add_f32 v43, v38, v39
    v_add_f32 v40, v40, v41
    v_add_f32 v42, v42, v43
    v_add_f32 v40, v40, v42
    s_nop 1
    v_add_f32_dpp v40, v40, v40 row_ror:8 row_mask:0xf bank_mask:0xf
    s_nop 1
    v_add_f32_dpp v40, v40, v40 row_ror:4 row_mask:0xf bank_mask:0xf
    s_nop 1
    v_add_f32_dpp v40, v40, v40 row_ror:2 row_mask:0xf bank_mask:0xf
    s_nop 1
    v_add_f32_dpp v40, v40, v40 row_ror:1 row_mask:0xf bank_mask:0xf
    v_mov_b32 v41, v40
    s_nop 1
    v_permlane16_swap_b32 v40, v41
    v_add_f32 v40, v40, v41
    v_mov_b32 v41, v40
    s_nop 1
    v_permlane32_swap_b32 v40, v41
    v_add_f32 v40, v40, v41
    v_mul_f32 v40, 0x3b000000, v40
    v_sub_f32 v42, v32, v40
    v_sub_f32 v43, v33, v40
    v_sub_f32 v44, v34, v40
    v_sub_f32 v45, v35, v40
    v_sub_f32 v46, v36, v40
    v_sub_f32 v47, v37, v40
    v_sub_f32 v48, v38, v40
    v_sub_f32 v49, v39, v40
    v_mul_f32 v41, v42, v42
    v_fmac_f32 v41, v43, v43
    v_fmac_f32 v41, v44, v44
    v_fmac_f32 v41, v45, v45
    v_fmac_f32 v41, v46, v46
    v_fmac_f32 v41, v47, v47
    v_fmac_f32 v41, v48, v48
    v_fmac_f32 v41, v49, v49
    s_nop 1
    v_add_f32_dpp v41, v41, v41 row_ror:8 row_mask:0xf bank_mask:0xf
    s_nop 1
    v_add_f32_dpp v41, v41, v41 row_ror:4 row_mask:0xf bank_mask:0xf
    s_nop 1
    v_add_f32_dpp v41, v41, v41 row_ror:2 row_mask:0xf bank_mask:0xf
    s_nop 1
    v_add_f32_dpp v41, v41, v41 row_ror:1 row_mask:0xf bank_mask:0xf
    v_mov_b32 v50, v41
    s_nop 1
    v_permlane16_swap_b32 v41, v50
    v_add_f32 v41, v41, v50
    v_mov_b32 v50, v41
    s_nop 1
    v_permlane32_swap_b32 v41, v50
    v_add_f32 v41, v41, v50
    v_mul_f32 v41, 0x3b000000, v41
    v_cvt_pk_bf16_f32 v41, v41, v41
    v_and_b32 v41, 0xffff0000, v41
    v_add_f32 v41, 0x3727c5ac, v41
    v_cvt_pk_bf16_f32 v41, v41, v41
    v_and_b32 v41, 0xffff0000, v41
    v_sqrt_f32 v41, v41
    s_nop 0
    v_cvt_pk_bf16_f32 v41, v41, v41
    v_and_b32 v41, 0xffff0000, v41
    v_rcp_f32 v41, v41
    v_cvt_pk_bf16_f32 v40, v40, v40
    v_and_b32 v40, 0xffff0000, v40
    v_sub_f32 v42, v32, v40
    v_sub_f32 v43, v33, v40
    v_sub_f32 v44, v34, v40
    v_sub_f32 v45, v35, v40
    v_sub_f32 v46, v36, v40
    v_sub_f32 v47, v37, v40
    v_sub_f32 v48, v38, v40
    v_sub_f32 v49, v39, v40
    v_cvt_pk_bf16_f32 v50, v42, v43
    v_lshlrev_b32 v42, 16, v50
    v_and_b32 v43, 0xffff0000, v50
    v_cvt_pk_bf16_f32 v50, v44, v45
    v_lshlrev_b32 v44, 16, v50
    v_and_b32 v45, 0xffff0000, v50
    v_cvt_pk_bf16_f32 v50, v46, v47
    v_lshlrev_b32 v46, 16, v50
    v_and_b32 v47, 0xffff0000, v50
    v_cvt_pk_bf16_f32 v50, v48, v49
    v_lshlrev_b32 v48, 16, v50
    v_and_b32 v49, 0xffff0000, v50
    v_mul_f32 v42, v42, v41
    v_mul_f32 v43, v43, v41
    v_mul_f32 v44, v44, v41
    v_mul_f32 v45, v45, v41
    v_mul_f32 v46, v46, v41
    v_mul_f32 v47, v47, v41
    v_mul_f32 v48, v48, v41
    v_mul_f32 v49, v49, v41
    v_cvt_pk_bf16_f32 v50, v42, v43
    v_cvt_pk_bf16_f32 v51, v44, v45
    v_cvt_pk_bf16_f32 v52, v46, v47
    v_cvt_pk_bf16_f32 v53, v48, v49
    v_lshrrev_b32 v32, 2, v1
    v_lshlrev_b32 v32, 6, v32
    v_and_b32 v33, 1, v1
    v_lshl_add_u32 v32, v33, 5, v32
    v_bfe_u32 v33, v1, 1, 1
    v_lshl_add_u32 v32, v33, 3, v32
    s_and_b32 s33, s32, 1
    s_mul_i32 s33, s33, 1040
    v_add_u32 v32, s33, v32
    ds_write2_b64 v32, v[50:51], v[52:53] offset0:0 offset1:2
    v_lshrrev_b32 v6, 2, v1
    v_lshlrev_b32 v6, 7, v6
    v_and_b32 v7, 3, v1
    v_lshl_add_u32 v6, v7, 3, v6
    s_lshl_b32 s33, s32, 5
    s_add_u32 s33, s33, 8192
    v_add_u32 v6, s33, v6
    v_and_b32 v7, 1, v2
    v_mul_u32_u24 v7, 1040, v7
    v_lshl_add_u32 v7, v3, 4, v7
    s_lshr_b32 s33, s29, 3
    s_lshl_b32 s33, s33, 8
    v_add_u32 v7, s33, v7
    s_lshl_b32 s33, s28, 14
    s_lshr_b32 s68, s29, 3
    s_lshl_b32 s68, s68, 11
    s_add_u32 s33, s33, s68
    s_and_b32 s68, s29, 7
    s_lshl_b32 s68, s68, 8
    s_add_u32 s33, s33, s68
    s_lshl_b32 s68, s32, 6
    s_add_u32 s33, s33, s68
    s_add_u32 s33, s33, 65536
    v_lshlrev_b32 v9, 13, v2
    v_lshl_add_u32 v9, v3, 4, v9
    v_add_u32 v9, s33, v9
    s_lshl_b32 s33, s28, 14
    s_lshl_b32 s68, s30, 13
    s_add_u32 s33, s33, s68
    s_lshl_b32 s68, s32, 9
    s_add_u32 s33, s33, s68
    s_add_u32 s33, s33, 65536
    v_lshrrev_b32 v29, 5, v1
    v_lshlrev_b32 v29, 12, v29
    v_and_b32 v10, 31, v1
    v_lshl_add_u32 v29, v10, 4, v29
    v_add_u32 v29, s33, v29
    s_waitcnt vmcnt(9)
    s_waitcnt lgkmcnt(0)
    s_barrier
    ds_read_b64_tr_b16 v[32:33], v6 offset:0
    ds_read_b64_tr_b16 v[34:35], v6 offset:2048
    ds_read_b128 v[192:195], v7 offset:0
    ds_read_b64_tr_b16 v[36:37], v6 offset:4096
    ds_read_b64_tr_b16 v[38:39], v6 offset:6144
    ds_read_b128 v[196:199], v7 offset:64
    ds_read_b64_tr_b16 v[40:41], v6 offset:8192
    ds_read_b64_tr_b16 v[42:43], v6 offset:10240
    ds_read_b128 v[200:203], v7 offset:128
    ds_read_b64_tr_b16 v[44:45], v6 offset:12288
    ds_read_b64_tr_b16 v[46:47], v6 offset:14336
    ds_read_b128 v[204:207], v7 offset:192
    s_waitcnt lgkmcnt(0)
    v_mfma_f32_16x16x32_bf16 v[208:211], v[32:35], v[192:195], 0
    v_mfma_f32_16x16x32_bf16 v[208:211], v[36:39], v[196:199], v[208:211]
    v_mfma_f32_16x16x32_bf16 v[208:211], v[40:43], v[200:203], v[208:211]
    v_mfma_f32_16x16x32_bf16 v[208:211], v[44:47], v[204:207], v[208:211]
    s_nop 7
    v_add_u32 v208, 0x100, v208
    v_add_u32 v209, 0x100, v209
    v_add_u32 v210, 0x100, v210
    v_add_u32 v211, 0x100, v211
    v_bfi_b32 v212, v22, s40, v208
    v_bfi_b32 v213, v22, s41, v209
    v_bfi_b32 v214, v22, s42, v210
    v_bfi_b32 v215, v22, s43, v211
    s_mov_b32 s68, 0x00030003
    s_mov_b32 s69, 0x00030003
    s_mov_b64 exec, s[68:69]
    global_store_dwordx4 v9, v[212:215], s[26:27] sc1
    s_mov_b64 exec, -1
    s_waitcnt vmcnt(7)
    s_add_u32 s33, s35, 32768
    s_and_b32 s33, s33, 0xffff
    s_add_u32 m0, s14, 8192
    s_nop 0
    buffer_load_dwordx4 v16, s[44:47], s33 offen nt lds
    s_waitcnt vmcnt(7)
    s_add_u32 s33, s35, 36864
    s_and_b32 s33, s33, 0xffff
    s_add_u32 m0, s14, 9216
    s_nop 0
    buffer_load_dwordx4 v17, s[44:47], s33 offen nt lds
    s_waitcnt vmcnt(7)
    s_add_u32 s33, s35, 40960
    s_and_b32 s33, s33, 0xffff
    s_add_u32 m0, s14, 10240
    s_nop 0
    buffer_load_dwordx4 v18, s[44:47], s33 offen nt lds
    s_waitcnt vmcnt(7)
    s_add_u32 s33, s35, 45056
    s_and_b32 s33, s33, 0xffff
    s_add_u32 m0, s14, 11264
    s_nop 0
    buffer_load_dwordx4 v19, s[44:47], s33 offen nt lds
    s_waitcnt vmcnt(7)
    s_add_u32 s33, s35, 49152
    s_and_b32 s33, s33, 0xffff
    s_add_u32 m0, s14, 12288
    s_nop 0
    buffer_load_dwordx4 v16, s[44:47], s33 offen nt lds
    s_waitcnt vmcnt(7)
    s_add_u32 s33, s35, 53248
    s_and_b32 s33, s33, 0xffff
    s_add_u32 m0, s14, 13312
    s_nop 0
    buffer_load_dwordx4 v17, s[44:47], s33 offen nt lds
    s_waitcnt vmcnt(7)
    s_add_u32 s33, s35, 57344
    s_and_b32 s33, s33, 0xffff
    s_add_u32 m0, s14, 14336
    s_nop 0
    buffer_load_dwordx4 v18, s[44:47], s33 offen nt lds
    s_waitcnt vmcnt(7)
    s_add_u32 s33, s35, 61440
    s_and_b32 s33, s33, 0xffff
    s_add_u32 m0, s14, 15360
    s_nop 0
    buffer_load_dwordx4 v19, s[44:47], s33 offen nt lds
    s_waitcnt vmcnt(7)
    s_add_u32 s33, s35, 0
    s_and_b32 s33, s33, 0xffff
    buffer_load_dwordx4 v[64:67], v20, s[48:51], s33 offen nt
    global_load_dwordx4 v[48:51], v29, s[26:27] sc1
    global_load_dwordx4 v[52:55], v29, s[26:27] offset:2048 sc1
    s_waitcnt vmcnt(7)
    s_add_u32 s33, s35, 4096
    s_and_b32 s33, s33, 0xffff
    buffer_load_dwordx4 v[68:71], v20, s[48:51], s33 offen nt
    s_waitcnt vmcnt(7)
    s_add_u32 s33, s35, 8192
    s_and_b32 s33, s33, 0xffff
    buffer_load_dwordx4 v[72:75], v20, s[48:51], s33 offen nt
    s_waitcnt vmcnt(7)
    s_add_u32 s33, s35, 12288
    s_and_b32 s33, s33, 0xffff
    buffer_load_dwordx4 v[76:79], v20, s[48:51], s33 offen nt
    s_waitcnt vmcnt(7)
    s_add_u32 s33, s35, 16384
    s_and_b32 s33, s33, 0xffff
    buffer_load_dwordx4 v[80:83], v20, s[48:51], s33 offen nt
    s_waitcnt vmcnt(7)
    s_add_u32 s33, s35, 20480
    s_and_b32 s33, s33, 0xffff
    buffer_load_dwordx4 v[84:87], v20, s[48:51], s33 offen nt
    s_waitcnt vmcnt(7)
    s_add_u32 s33, s35, 24576
    s_and_b32 s33, s33, 0xffff
    buffer_load_dwordx4 v[88:91], v20, s[48:51], s33 offen nt
    v_or_b32 v9, 0, v3
    v_xor_b32 v9, v9, v2
    v_lshlrev_b32 v9, 4, v9
    v_and_b32 v10, 3, v2
    v_lshl_add_u32 v9, v10, 10, v9
    v_lshrrev_b32 v10, 2, v2
    v_lshl_add_u32 v9, v10, 8, v9
    v_add_u32 v32, s14, v9
    v_or_b32 v9, 4, v3
    v_xor_b32 v9, v9, v2
    v_lshlrev_b32 v9, 4, v9
    v_and_b32 v10, 3, v2
    v_lshl_add_u32 v9, v10, 10, v9
    v_lshrrev_b32 v10, 2, v2
    v_lshl_add_u32 v9, v10, 8, v9
    v_add_u32 v33, s14, v9
    v_or_b32 v9, 8, v3
    v_xor_b32 v9, v9, v2
    v_lshlrev_b32 v9, 4, v9
    v_and_b32 v10, 3, v2
    v_lshl_add_u32 v9, v10, 10, v9
    v_lshrrev_b32 v10, 2, v2
    v_lshl_add_u32 v9, v10, 8, v9
    v_add_u32 v34, s14, v9
    v_or_b32 v9, 12, v3
    v_xor_b32 v9, v9, v2
    v_lshlrev_b32 v9, 4, v9
    v_and_b32 v10, 3, v2
    v_lshl_add_u32 v9, v10, 10, v9
    v_lshrrev_b32 v10, 2, v2
    v_lshl_add_u32 v9, v10, 8, v9
    v_add_u32 v35, s14, v9
    s_waitcnt vmcnt(6)
    v_xor_b32 v48, s40, v48
    v_xor_b32 v49, s41, v49
    v_xor_b32 v50, s42, v50
    v_xor_b32 v51, s43, v51
    v_xor_b32 v52, s40, v52
    v_xor_b32 v53, s41, v53
    v_xor_b32 v54, s42, v54
    v_xor_b32 v55, s43, v55
    v_or3_b32 v4, v48, v49, v50
    v_or3_b32 v4, v51, v52, v4
    v_or3_b32 v4, v53, v54, v4
    v_or_b32 v4, v55, v4
    v_and_b32 v5, 0xff, v4
    v_cmp_ne_u32 vcc, 0, v5
    s_cbranch_vccnz Lq_loop_entry
    s_branch Lq_ok
Lq_loop_entry:
    s_mov_b32 s64, 0
Lp_1:
    global_load_dwordx4 v[48:51], v29, s[26:27] sc1
    global_load_dwordx4 v[52:55], v29, s[26:27] offset:2048 sc1
    s_waitcnt vmcnt(0)
    v_xor_b32 v48, s40, v48
    v_xor_b32 v49, s41, v49
    v_xor_b32 v50, s42, v50
    v_xor_b32 v51, s43, v51
    v_xor_b32 v52, s40, v52
    v_xor_b32 v53, s41, v53
    v_xor_b32 v54, s42, v54
    v_xor_b32 v55, s43, v55
    v_or3_b32 v4, v48, v49, v50
    v_or3_b32 v4, v51, v52, v4
    v_or3_b32 v4, v53, v54, v4
    v_or_b32 v4, v55, v4
    v_and_b32 v5, 0xff, v4
    v_cmp_ne_u32 vcc, 0, v5
    s_cbranch_vccz Ld_2
    s_add_u32 s64, s64, 1
    s_cmp_le_u32 s64, 2097152
    s_cbranch_scc1 Lp_1
    s_branch Lfin
Ld_2:
Lq_ok:
    s_add_u32 s33, s35, 28672
    s_and_b32 s33, s33, 0xffff
    buffer_load_dwordx4 v[92:95], v20, s[48:51], s33 offen nt
    s_add_u32 s33, s35, 32768
    s_and_b32 s33, s33, 0xffff
    buffer_load_dwordx4 v[96:99], v20, s[48:51], s33 offen nt
    s_add_u32 s33, s35, 36864
    s_and_b32 s33, s33, 0xffff
    buffer_load_dwordx4 v[100:103], v20, s[48:51], s33 offen nt
    s_add_u32 s33, s35, 40960
    s_and_b32 s33, s33, 0xffff
    buffer_load_dwordx4 v[104:107], v20, s[48:51], s33 offen nt
    s_add_u32 s33, s35, 45056
    s_and_b32 s33, s33, 0xffff
    buffer_load_dwordx4 v[108:111], v20, s[48:51], s33 offen nt
    s_add_u32 s33, s35, 49152
    s_and_b32 s33, s33, 0xffff
    buffer_load_dwordx4 v[112:115], v20, s[48:51], s33 offen nt
    ds_read_b128 a[0:3], v32 offset:0
    ds_read_b128 a[4:7], v33 offset:0
    ds_read_b128 a[8:11], v34 offset:0
    ds_read_b128 a[12:15], v35 offset:0
    ds_read_b128 a[16:19], v32 offset:4096
    ds_read_b128 a[20:23], v33 offset:4096
    ds_read_b128 a[24:27], v34 offset:4096
    ds_read_b128 a[28:31], v35 offset:4096
    ds_read_b128 a[32:35], v32 offset:8192
    ds_read_b128 a[36:39], v33 offset:8192
    ds_read_b128 a[40:43], v34 offset:8192
    ds_read_b128 a[44:47], v35 offset:8192
    ds_read_b128 a[48:51], v32 offset:12288
    ds_read_b128 a[52:55], v33 offset:12288
    ds_read_b128 a[56:59], v34 offset:12288
    ds_read_b128 a[60:63], v35 offset:12288
    v_and_b32 v5, 0x100, v4
    v_cmp_ne_u32 vcc, 0, v5
    s_nop 1
    s_cmp_eq_u64 vcc, 0
    s_cselect_b32 s33, 1, 0
    v_mov_b32 v6, s33
    v_and_b32 v48, 0xfffffe00, v48
    v_and_b32 v49, 0xfffffe00, v49
    v_and_b32 v50, 0xfffffe00, v50
    v_and_b32 v51, 0xfffffe00, v51
    v_and_b32 v52, 0xfffffe00, v52
    v_and_b32 v53, 0xfffffe00, v53
    v_and_b32 v54, 0xfffffe00, v54
    v_and_b32 v55, 0xfffffe00, v55
    v_add_f32 v48, v48, v52
    v_add_f32 v49, v49, v53
    v_add_f32 v50, v50, v54
    v_add_f32 v51, v51, v55
    v_mov_b32 v52, v48
    v_mov_b32 v53, v49
    v_mov_b32 v54, v50
    v_mov_b32 v55, v51
    v_permlane32_swap_b32 v48, v52
    v_permlane32_swap_b32 v49, v53
    v_permlane32_swap_b32 v50, v54
    v_permlane32_swap_b32 v51, v55
    v_add_f32 v48, v48, v52
    v_add_f32 v49, v49, v53
    v_add_f32 v50, v50, v54
    v_add_f32 v51, v51, v55
    v_cvt_pk_bf16_f32 v48, v48, v49
    v_cvt_pk_bf16_f32 v49, v50, v51
    v_and_b32 v7, 31, v1
    v_lshlrev_b32 v7, 3, v7
    s_mul_i32 s33, s32, 320
    v_add_u32 v7, s33, v7
    ds_write_b64 v7, v[48:49] offset:2304
    s_lshl_b32 s33, s32, 2
    v_mov_b32 v7, s33
    ds_write_b32 v7, v6 offset:3712
    v_and_b32 v7, 3, v2
    v_mul_u32_u24 v7, 320, v7
    v_lshl_add_u32 v7, v3, 4, v7
    v_mov_b32 v8, 0
    s_waitcnt lgkmcnt(0)
    s_barrier
    ds_read_b128 a[64:67], v7 offset:2304
    ds_read_b128 a[68:71], v7 offset:2368
    ds_read_b128 a[72:75], v7 offset:2432
    ds_read_b128 a[76:79], v7 offset:2496
    ds_read_b128 v[8:11], v8 offset:3712
    s_waitcnt lgkmcnt(0)
    v_and_b32 v8, v8, v9
    v_and_b32 v10, v10, v11
    v_and_b32 v8, v8, v10
    v_mfma_f32_16x16x32_bf16 v[240:243], a[0:3], a[64:67], 0
    v_mfma_f32_16x16x32_bf16 v[244:247], a[16:19], a[64:67], 0
    v_mfma_f32_16x16x32_bf16 v[248:251], a[32:35], a[64:67], 0
    v_mfma_f32_16x16x32_bf16 v[252:255], a[48:51], a[64:67], 0
    v_mfma_f32_16x16x32_bf16 v[240:243], a[4:7], a[68:71], v[240:243]
    v_mfma_f32_16x16x32_bf16 v[244:247], a[20:23], a[68:71], v[244:247]
    v_mfma_f32_16x16x32_bf16 v[248:251], a[36:39], a[68:71], v[248:251]
    v_mfma_f32_16x16x32_bf16 v[252:255], a[52:55], a[68:71], v[252:255]
    v_mfma_f32_16x16x32_bf16 v[240:243], a[8:11], a[72:75], v[240:243]
    v_mfma_f32_16x16x32_bf16 v[244:247], a[24:27], a[72:75], v[244:247]
    v_mfma_f32_16x16x32_bf16 v[248:251], a[40:43], a[72:75], v[248:251]
    v_mfma_f32_16x16x32_bf16 v[252:255], a[56:59], a[72:75], v[252:255]
    v_mfma_f32_16x16x32_bf16 v[240:243], a[12:15], a[76:79], v[240:243]
    v_mfma_f32_16x16x32_bf16 v[244:247], a[28:31], a[76:79], v[244:247]
    v_mfma_f32_16x16x32_bf16 v[248:251], a[44:47], a[76:79], v[248:251]
    v_mfma_f32_16x16x32_bf16 v[252:255], a[60:63], a[76:79], v[252:255]
    s_add_u32 s33, s35, 53248
    s_and_b32 s33, s33, 0xffff
    buffer_load_dwordx4 v[116:119], v20, s[48:51], s33 offen nt
    s_add_u32 s33, s35, 57344
    s_and_b32 s33, s33, 0xffff
    buffer_load_dwordx4 v[120:123], v20, s[48:51], s33 offen nt
    s_add_u32 s33, s35, 61440
    s_and_b32 s33, s33, 0xffff
    buffer_load_dwordx4 v[124:127], v20, s[48:51], s33 offen nt
    v_readfirstlane_b32 s61, v8
    v_mov_b32_dpp v240, v244 quad_perm:[0,1,2,3] row_mask:0xf bank_mask:0x2
    s_nop 1
    v_mov_b32_dpp v240, v248 quad_perm:[0,1,2,3] row_mask:0xf bank_mask:0x4
    s_nop 1
    v_mov_b32_dpp v240, v252 quad_perm:[0,1,2,3] row_mask:0xf bank_mask:0x8
    v_mov_b32_dpp v241, v245 quad_perm:[0,1,2,3] row_mask:0xf bank_mask:0x2
    s_nop 1
    v_mov_b32_dpp v241, v249 quad_perm:[0,1,2,3] row_mask:0xf bank_mask:0x4
    s_nop 1
    v_mov_b32_dpp v241, v253 quad_perm:[0,1,2,3] row_mask:0xf bank_mask:0x8
    v_mov_b32_dpp v242, v246 quad_perm:[0,1,2,3] row_mask:0xf bank_mask:0x2
    s_nop 1
    v_mov_b32_dpp v242, v250 quad_perm:[0,1,2,3] row_mask:0xf bank_mask:0x4
    s_nop 1
    v_mov_b32_dpp v242, v254 quad_perm:[0,1,2,3] row_mask:0xf bank_mask:0x8
    v_mov_b32_dpp v243, v247 quad_perm:[0,1,2,3] row_mask:0xf bank_mask:0x2
    s_nop 1
    v_mov_b32_dpp v243, v251 quad_perm:[0,1,2,3] row_mask:0xf bank_mask:0x4
    s_nop 1
    v_mov_b32_dpp v243, v255 quad_perm:[0,1,2,3] row_mask:0xf bank_mask:0x8
    v_cvt_pk_bf16_f32 v4, v240, v241
    v_lshlrev_b32 v240, 16, v4
    v_and_b32 v241, 0xffff0000, v4
    v_cvt_pk_bf16_f32 v5, v242, v243
    v_lshlrev_b32 v242, 16, v5
    v_and_b32 v243, 0xffff0000, v5
    v_mul_f32 v240, 0x3db504f3, v240
    v_mul_f32 v241, 0x3db504f3, v241
    v_mul_f32 v242, 0x3db504f3, v242
    v_mul_f32 v243, 0x3db504f3, v243
    v_cvt_pk_bf16_f32 v4, v240, v241
    v_lshlrev_b32 v240, 16, v4
    v_and_b32 v241, 0xffff0000, v4
    v_cvt_pk_bf16_f32 v5, v242, v243
    v_lshlrev_b32 v242, 16, v5
    v_and_b32 v243, 0xffff0000, v5
    v_max3_f32 v4, v240, v241, v242
    v_max_f32 v4, v4, v243
    s_nop 1
    v_max_f32_dpp v4, v4, v4 row_ror:4 row_mask:0xf bank_mask:0xf
    s_nop 1
    v_max_f32_dpp v4, v4, v4 row_ror:8 row_mask:0xf bank_mask:0xf
    v_mov_b32 v5, v4
    s_nop 1
    v_permlane16_swap_b32 v4, v5
    v_max_f32 v4, v4, v5
    v_mov_b32 v5, v4
    s_nop 1
    v_permlane32_swap_b32 v4, v5
    v_max_f32 v4, v4, v5
    v_and_b32 v6, 3, v1
    v_lshlrev_b32 v6, 4, v6
    s_lshl_b32 s33, s32, 2
    v_add_u32 v7, s33, v6
    s_mov_b64 exec, 15
    ds_write_b32 v7, v4 offset:3584
    s_mov_b64 exec, -1
    s_waitcnt lgkmcnt(0)
    s_barrier
    ds_read_b128 v[8:11], v6 offset:3584
    s_waitcnt lgkmcnt(0)
    v_max3_f32 v8, v8, v9, v10
    v_max_f32 v30, v8, v11
    v_sub_f32 v240, v240, v30
    v_sub_f32 v241, v241, v30
    v_sub_f32 v242, v242, v30
    v_sub_f32 v243, v243, v30
    v_mul_f32 v240, 0x3fb8aa3b, v240
    v_mul_f32 v241, 0x3fb8aa3b, v241
    v_mul_f32 v242, 0x3fb8aa3b, v242
    v_mul_f32 v243, 0x3fb8aa3b, v243
    v_exp_f32 v240, v240
    v_exp_f32 v241, v241
    v_exp_f32 v242, v242
    v_exp_f32 v243, v243
    v_add_f32 v4, v240, v241
    v_add_f32 v5, v242, v243
    v_cvt_pk_bf16_f32 v208, v240, v241
    v_cvt_pk_bf16_f32 v209, v242, v243
    v_add_f32 v4, v4, v5
    s_nop 1
    v_add_f32_dpp v4, v4, v4 row_ror:4 row_mask:0xf bank_mask:0xf
    s_nop 1
    v_add_f32_dpp v4, v4, v4 row_ror:8 row_mask:0xf bank_mask:0xf
    v_mov_b32_dpp v210, v208 row_shl:4 row_mask:0xf bank_mask:0xf
    v_mov_b32_dpp v211, v209 row_shl:4 row_mask:0xf bank_mask:0xf
    v_mov_b32_dpp v212, v208 row_shl:8 row_mask:0xf bank_mask:0xf
    v_mov_b32_dpp v213, v209 row_shl:8 row_mask:0xf bank_mask:0xf
    v_mov_b32_dpp v214, v208 row_shl:12 row_mask:0xf bank_mask:0xf
    v_mov_b32_dpp v215, v209 row_shl:12 row_mask:0xf bank_mask:0xf
    v_mov_b32 v5, v4
    s_nop 1
    v_permlane16_swap_b32 v4, v5
    v_add_f32 v4, v4, v5
    v_mov_b32 v5, v4
    s_nop 1
    v_permlane32_swap_b32 v4, v5
    v_add_f32 v4, v4, v5
    s_mov_b64 exec, 15
    ds_write_b32 v7, v4 offset:3648
    s_mov_b64 exec, -1
    s_waitcnt lgkmcnt(0)
    s_barrier
    s_cmp_lg_u32 s32, 0
    s_cbranch_scc1 Lml_skip
    ds_read_b128 v[8:11], v6 offset:3648
    s_lshl_b32 s33, s28, 11
    s_lshl_b32 s68, s29, 6
    s_add_u32 s33, s33, s68
    s_add_u32 s33, s33, 196608
    v_add_u32 v7, s33, v6
    v_mov_b32 v12, 0
    s_waitcnt lgkmcnt(0)
    v_add_f32 v8, v8, v9
    v_add_f32 v10, v10, v11
    v_add_f32 v8, v8, v10
    v_bfi_b32 v48, v23, s36, v30
    v_bfi_b32 v49, v23, s37, v8
    v_bfi_b32 v50, v23, s38, v12
    v_bfi_b32 v51, v23, s39, v12
    s_mov_b64 exec, 15
    s_cmp_eq_u32 s61, 0
    s_cbranch_scc1 Lg_3
    global_store_dwordx4 v7, v[48:51], s[26:27]
    s_branch Le_4
Lg_3:
    global_store_dwordx4 v7, v[48:51], s[26:27] sc1
Le_4:
    s_mov_b64 exec, -1
Lml_skip:
    v_lshl_add_u32 v9, v2, 2, v3
    v_lshlrev_b32 v9, 7, v9
    s_lshl_b32 s33, s32, 11
    s_add_u32 s33, s33, 8192
    v_add_u32 v9, s33, v9
    v_xor_b32 v10, 0, v2
    v_lshl_add_u32 v224, v10, 4, v9
    v_xor_b32 v10, 1, v2
    v_lshl_add_u32 v225, v10, 4, v9
    v_xor_b32 v10, 2, v2
    v_lshl_add_u32 v226, v10, 4, v9
    v_xor_b32 v10, 3, v2
    v_lshl_add_u32 v227, v10, 4, v9
    v_xor_b32 v10, 4, v2
    v_lshl_add_u32 v228, v10, 4, v9
    v_xor_b32 v10, 5, v2
    v_lshl_add_u32 v229, v10, 4, v9
    v_xor_b32 v10, 6, v2
    v_lshl_add_u32 v230, v10, 4, v9
    v_xor_b32 v10, 7, v2
    v_lshl_add_u32 v231, v10, 4, v9
    v_lshrrev_b32 v9, 3, v0
    v_lshlrev_b32 v9, 7, v9
    v_lshrrev_b32 v10, 5, v0
    v_and_b32 v11, 7, v0
    v_xor_b32 v10, v10, v11
    v_lshl_add_u32 v232, v10, 4, v9
    s_lshl_b32 s33, s28, 16
    s_lshl_b32 s68, s29, 11
    s_add_u32 s33, s33, s68
    s_add_u32 s33, s33, 262144
    v_lshlrev_b32 v9, 4, v0
    v_add_u32 v233, s33, v9
    s_cmp_ge_u32 s29, 16
    s_cbranch_scc1 LroleF
    s_lshl_b32 s33, s28, 9
    s_lshl_b32 s68, s29, 5
    s_add_u32 s33, s33, s68
    v_lshl_add_u32 v9, v3, 1, s33
    v_lshlrev_b32 v9, 10, v9
    v_lshl_add_u32 v9, v2, 4, v9
    s_lshl_b32 s33, s32, 8
    v_add_u32 v9, s33, v9
    v_mov_b32 v246, v9
    v_add_u32 v10, 0, v246
    global_load_dwordx4 v[160:163], v10, s[12:13] nt
    v_add_u32 v10, 8192, v246
    global_load_dwordx4 v[164:167], v10, s[12:13] nt
    v_add_u32 v10, 16384, v246
    global_load_dwordx4 v[168:171], v10, s[12:13] nt
    v_add_u32 v10, 24576, v246
    global_load_dwordx4 v[172:175], v10, s[12:13] nt
    v_add_u32 v10, 1024, v246
    global_load_dwordx4 v[176:179], v10, s[12:13] nt
    v_add_u32 v10, 9216, v246
    global_load_dwordx4 v[180:183], v10, s[12:13] nt
    v_add_u32 v10, 17408, v246
    global_load_dwordx4 v[184:187], v10, s[12:13] nt
    v_add_u32 v10, 25600, v246
    global_load_dwordx4 v[188:191], v10, s[12:13] nt
    s_lshr_b32 s33, s29, 2
    s_lshl_b32 s33, s33, 8
    s_and_b32 s68, s28, 1
    s_lshl_b32 s68, s68, 7
    s_add_u32 s33, s33, s68
    s_and_b32 s68, s29, 3
    s_lshl_b32 s68, s68, 5
    s_add_u32 s33, s33, s68
    s_lshr_b32 s68, s28, 1
    s_lshl_b32 s68, s68, 2
    s_add_u32 s33, s33, s68
    v_and_b32 v10, 1, v1
    v_lshl_add_u32 v245, v10, 4, s33
    v_and_b32 v10, 1, v3
    v_lshl_add_u32 v245, v10, 1, v245
    v_lshrrev_b32 v10, 1, v3
    v_lshl_add_u32 v245, v10, 10, v245
    global_load_ushort v234, v245, s[4:5]
    v_subrev_u32 v10, 8, v1
    s_lshl_b32 s68, s32, 2
    v_add_u32 v10, s68, v10
    s_lshl_b32 s68, s28, 11
    s_add_u32 s68, s68, 196608
    v_lshl_add_u32 v9, v10, 7, s68
    s_lshl_b32 s68, s32, 3
    v_add_u32 v10, s68, v1
    s_lshl_b32 s33, s28, 16
    s_lshl_b32 s68, s29, 7
    s_add_u32 s33, s33, s68
    s_add_u32 s33, s33, 262144
    v_lshl_add_u32 v12, v10, 11, s33
    v_cmp_gt_u32 vcc, 8, v1
    s_nop 1
    v_cndmask_b32 v9, v9, v12, vcc
    s_mov_b64 exec, 0xfff
    global_load_dword v236, v9, s[26:27]
    s_mov_b64 exec, -1
    s_lshr_b32 s15, s32, 1
    s_and_b32 s24, s32, 1
    v_lshrrev_b32 v9, 2, v1
    s_lshl_b32 s33, s15, 4
    v_add_u32 v9, s33, v9
    s_lshl_b32 s33, s28, 11
    s_lshr_b32 s68, s29, 2
    s_lshl_b32 s68, s68, 4
    s_add_u32 s33, s33, s68
    s_add_u32 s25, s33, 196608
    v_lshl_add_u32 v32, v9, 6, s25
    s_lshl_b32 s33, s28, 16
    s_lshl_b32 s68, s29, 7
    s_add_u32 s33, s33, s68
    s_add_u32 s69, s33, 262144
    s_lshl_b32 s68, s24, 6
    s_add_u32 s33, s69, s68
    v_lshl_add_u32 v33, v9, 11, s33
    v_and_b32 v12, 3, v1
    v_lshl_add_u32 v33, v12, 4, v33
    s_lshl_b32 s33, s15, 6
    s_lshl_b32 s68, s24, 5
    s_add_u32 s33, s33, s68
    v_lshl_add_u32 v34, v12, 3, s33
    v_lshrrev_b32 v13, 1, v3
    v_and_b32 v14, 1, v3
    v_lshl_add_u32 v13, v14, 1, v13
    v_lshl_add_u32 v34, v13, 1, v34
    v_and_b32 v13, 1, v2
    v_lshlrev_b32 v13, 6, v13
    v_lshl_add_u32 v35, v3, 4, v13
    s_lshl_b32 s33, s28, 16
    s_add_u32 s15, s33, 786432
    s_lshl_b32 s68, s29, 12
    s_add_u32 s33, s15, s68
    s_lshl_b32 s68, s32, 10
    s_add_u32 s33, s33, s68
    v_lshl_add_u32 v36, v2, 4, s33
    s_lshl_b32 s33, s29, 8
    v_lshl_add_u32 v9, v2, 4, s33
    v_lshl_add_u32 v10, v3, 12, v9
    v_add_u32 v37, s15, v10
    v_add_u32 v38, 16384, v37
    v_add_u32 v39, 32768, v37
    v_add_u32 v40, 49152, v37
    s_lshl_b32 s33, s28, 12
    s_add_u32 s33, s33, 2162688
    v_lshl_add_u32 v41, v3, 15, v9
    v_add_u32 v41, s33, v41
    v_add_u32 v44, 0x20000, v41
    s_lshl_b32 s33, s28, 15
    s_add_u32 s33, s33, 2162688
    s_lshr_b32 s68, s29, 2
    s_lshl_b32 s68, s68, 10
    s_add_u32 s33, s33, s68
    s_lshr_b32 s68, s28, 1
    s_lshl_b32 s68, s68, 8
    s_add_u32 s33, s33, s68
    s_and_b32 s68, s28, 1
    s_lshl_b32 s68, s68, 7
    s_add_u32 s33, s33, s68
    s_and_b32 s68, s29, 3
    s_lshl_b32 s68, s68, 5
    s_add_u32 s33, s33, s68
    v_bfe_u32 v11, v1, 1, 3
    v_lshlrev_b32 v11, 12, v11
    v_and_b32 v12, 1, v1
    v_lshl_add_u32 v11, v12, 4, v11
    v_add_u32 v42, s33, v11
    s_mul_i32 s33, s28, 14336
    s_lshr_b32 s68, s29, 2
    s_lshl_b32 s68, s68, 7
    s_add_u32 s33, s33, s68
    s_and_b32 s68, s29, 3
    s_lshl_b32 s68, s68, 5
    s_add_u32 s33, s33, s68
    s_add_u32 s33, s33, 1638400
    v_lshrrev_b32 v11, 1, v1
    v_cmp_gt_u32 vcc, 28, v11
    s_nop 1
    v_cndmask_b32 v11, 0, v11, vcc
    v_cndmask_b32 v244, 0, 1.0, vcc
    v_lshlrev_b32 v11, 9, v11
    v_lshl_add_u32 v11, v12, 4, v11
    v_add_u32 v45, s33, v11
    s_waitcnt vmcnt(18)
    v_perm_b32 v128, v68, v64, s65
    v_perm_b32 v132, v68, v64, s66
    v_perm_b32 v136, v69, v65, s65
    v_perm_b32 v140, v69, v65, s66
    v_perm_b32 v144, v70, v66, s65
    v_perm_b32 v148, v70, v66, s66
    v_perm_b32 v152, v71, v67, s65
    v_perm_b32 v156, v71, v67, s66
    v_perm_b32 v129, v76, v72, s65
    v_perm_b32 v133, v76, v72, s66
    v_perm_b32 v137, v77, v73, s65
    v_perm_b32 v141, v77, v73, s66
    v_perm_b32 v145, v78, v74, s65
    v_perm_b32 v149, v78, v74, s66
    v_perm_b32 v153, v79, v75, s65
    v_perm_b32 v157, v79, v75, s66
    v_perm_b32 v130, v84, v80, s65
    v_perm_b32 v134, v84, v80, s66
    v_perm_b32 v138, v85, v81, s65
    v_perm_b32 v142, v85, v81, s66
    v_perm_b32 v146, v86, v82, s65
    v_perm_b32 v150, v86, v82, s66
    v_perm_b32 v154, v87, v83, s65
    v_perm_b32 v158, v87, v83, s66
    v_perm_b32 v131, v92, v88, s65
    v_perm_b32 v135, v92, v88, s66
    v_perm_b32 v139, v93, v89, s65
    v_perm_b32 v143, v93, v89, s66
    v_perm_b32 v147, v94, v90, s65
    v_perm_b32 v151, v94, v90, s66
    v_perm_b32 v155, v95, v91, s65
    v_perm_b32 v159, v95, v91, s66
    v_mfma_f32_16x16x32_bf16 a[80:83], v[128:131], v[208:211], 0
    v_mfma_f32_16x16x32_bf16 a[84:87], v[132:135], v[208:211], 0
    v_mfma_f32_16x16x32_bf16 a[88:91], v[136:139], v[208:211], 0
    v_mfma_f32_16x16x32_bf16 a[92:95], v[140:143], v[208:211], 0
    v_mfma_f32_16x16x32_bf16 a[96:99], v[144:147], v[208:211], 0
    v_mfma_f32_16x16x32_bf16 a[100:103], v[148:151], v[208:211], 0
    v_mfma_f32_16x16x32_bf16 a[104:107], v[152:155], v[208:211], 0
    v_mfma_f32_16x16x32_bf16 a[108:111], v[156:159], v[208:211], 0
    s_waitcnt vmcnt(16)
    v_perm_b32 v128, v100, v96, s65
    v_perm_b32 v132, v100, v96, s66
    v_perm_b32 v136, v101, v97, s65
    v_perm_b32 v140, v101, v97, s66
    v_perm_b32 v144, v102, v98, s65
    v_perm_b32 v148, v102, v98, s66
    v_perm_b32 v152, v103, v99, s65
    v_perm_b32 v156, v103, v99, s66
    s_waitcnt vmcnt(14)
    v_perm_b32 v129, v108, v104, s65
    v_perm_b32 v133, v108, v104, s66
    v_perm_b32 v137, v109, v105, s65
    v_perm_b32 v141, v109, v105, s66
    v_perm_b32 v145, v110, v106, s65
    v_perm_b32 v149, v110, v106, s66
    v_perm_b32 v153, v111, v107, s65
    v_perm_b32 v157, v111, v107, s66
    s_waitcnt vmcnt(12)
    v_perm_b32 v130, v116, v112, s65
    v_perm_b32 v134, v116, v112, s66
    v_perm_b32 v138, v117, v113, s65
    v_perm_b32 v142, v117, v113, s66
    v_perm_b32 v146, v118, v114, s65
    v_perm_b32 v150, v118, v114, s66
    v_perm_b32 v154, v119, v115, s65
    v_perm_b32 v158, v119, v115, s66
    s_waitcnt vmcnt(10)
    v_perm_b32 v131, v124, v120, s65
    v_perm_b32 v135, v124, v120, s66
    v_perm_b32 v139, v125, v121, s65
    v_perm_b32 v143, v125, v121, s66
    v_perm_b32 v147, v126, v122, s65
    v_perm_b32 v151, v126, v122, s66
    v_perm_b32 v155, v127, v123, s65
    v_perm_b32 v159, v127, v123, s66
    v_mfma_f32_16x16x32_bf16 a[80:83], v[128:131], v[212:215], a[80:83]
    v_mfma_f32_16x16x32_bf16 a[84:87], v[132:135], v[212:215], a[84:87]
    v_mfma_f32_16x16x32_bf16 a[88:91], v[136:139], v[212:215], a[88:91]
    v_mfma_f32_16x16x32_bf16 a[92:95], v[140:143], v[212:215], a[92:95]
    v_mfma_f32_16x16x32_bf16 a[96:99], v[144:147], v[212:215], a[96:99]
    v_mfma_f32_16x16x32_bf16 a[100:103], v[148:151], v[212:215], a[100:103]
    v_mfma_f32_16x16x32_bf16 a[104:107], v[152:155], v[212:215], a[104:107]
    v_mfma_f32_16x16x32_bf16 a[108:111], v[156:159], v[212:215], a[108:111]
    s_mov_b32 s68, 0x000f000f
    s_mov_b32 s69, 0x000f000f
    s_mov_b64 exec, s[68:69]
    ds_write_b128 v224, a[80:83]
    ds_write_b128 v225, a[84:87]
    ds_write_b128 v226, a[88:91]
    ds_write_b128 v227, a[92:95]
    ds_write_b128 v228, a[96:99]
    ds_write_b128 v229, a[100:103]
    ds_write_b128 v230, a[104:107]
    ds_write_b128 v231, a[108:111]
    s_mov_b64 exec, -1
    s_waitcnt lgkmcnt(0)
    s_barrier
    s_cmp_ge_u32 s32, 2
    s_cbranch_scc1 Lopskip_5
    ds_read_b128 v[192:195], v232 offset:8192
    ds_read_b128 v[196:199], v232 offset:10240
    ds_read_b128 v[200:203], v232 offset:12288
    ds_read_b128 v[204:207], v232 offset:14336
    s_waitcnt lgkmcnt(0)
    v_add_f32 v192, v192, v196
    v_add_f32 v200, v200, v204
    v_add_f32 v193, v193, v197
    v_add_f32 v201, v201, v205
    v_add_f32 v194, v194, v198
    v_add_f32 v202, v202, v206
    v_add_f32 v195, v195, v199
    v_add_f32 v203, v203, v207
    v_add_f32 v192, v192, v200
    v_add_f32 v193, v193, v201
    v_add_f32 v194, v194, v202
    v_add_f32 v195, v195, v203
    v_bfi_b32 v196, v23, s36, v192
    v_bfi_b32 v197, v23, s37, v193
    v_bfi_b32 v198, v23, s38, v194
    v_bfi_b32 v199, v23, s39, v195
    s_cmp_eq_u32 s61, 0
    s_cbranch_scc1 Lg_6
    global_store_dwordx4 v233, v[196:199], s[26:27]
    s_branch Le_7
Lg_6:
    global_store_dwordx4 v233, v[196:199], s[26:27] sc1
Le_7:
Lopskip_5:
    global_load_dwordx4 v[56:59], v32, s[26:27] sc1
    global_load_dwordx4 v[48:51], v33, s[26:27] sc1
    s_waitcnt vmcnt(10)
    v_perm_b32 v128, v164, v160, s65
    v_perm_b32 v132, v164, v160, s66
    v_perm_b32 v136, v165, v161, s65
    v_perm_b32 v140, v165, v161, s66
    v_perm_b32 v144, v166, v162, s65
    v_perm_b32 v148, v166, v162, s66
    v_perm_b32 v152, v167, v163, s65
    v_perm_b32 v156, v167, v163, s66
    s_waitcnt vmcnt(8)
    v_perm_b32 v129, v172, v168, s65
    v_perm_b32 v133, v172, v168, s66
    v_perm_b32 v137, v173, v169, s65
    v_perm_b32 v141, v173, v169, s66
    v_perm_b32 v145, v174, v170, s65
    v_perm_b32 v149, v174, v170, s66
    v_perm_b32 v153, v175, v171, s65
    v_perm_b32 v157, v175, v171, s66
    s_waitcnt vmcnt(6)
    v_perm_b32 v130, v180, v176, s65
    v_perm_b32 v134, v180, v176, s66
    v_perm_b32 v138, v181, v177, s65
    v_perm_b32 v142, v181, v177, s66
    v_perm_b32 v146, v182, v178, s65
    v_perm_b32 v150, v182, v178, s66
    v_perm_b32 v154, v183, v179, s65
    v_perm_b32 v158, v183, v179, s66
    s_waitcnt vmcnt(4)
    v_perm_b32 v131, v188, v184, s65
    v_perm_b32 v135, v188, v184, s66
    v_perm_b32 v139, v189, v185, s65
    v_perm_b32 v143, v189, v185, s66
    v_perm_b32 v147, v190, v186, s65
    v_perm_b32 v151, v190, v186, s66
    v_perm_b32 v155, v191, v187, s65
    v_perm_b32 v159, v191, v187, s66
    s_waitcnt vmcnt(1)
    v_xor_b32 v56, s36, v56
    v_xor_b32 v57, s37, v57
    v_xor_b32 v58, s38, v58
    v_xor_b32 v59, s39, v59
    v_or3_b32 v4, v56, v57, v58
    v_or_b32 v4, v59, v4
    v_and_b32 v5, 0xff, v4
    v_cmp_ne_u32 vcc, 0, v5
    s_cbranch_vccz Lmlok_8
    s_mov_b32 s64, 0
Lp_9:
    global_load_dwordx4 v[56:59], v32, s[26:27] sc1
    s_waitcnt vmcnt(0)
    v_xor_b32 v56, s36, v56
    v_xor_b32 v57, s37, v57
    v_xor_b32 v58, s38, v58
    v_xor_b32 v59, s39, v59
    v_or3_b32 v4, v56, v57, v58
    v_or_b32 v4, v59, v4
    v_and_b32 v5, 0xff, v4
    v_cmp_ne_u32 vcc, 0, v5
    s_cbranch_vccz Ld_10
    s_nop 0
    s_mov_b64 exec, vcc
    s_add_u32 s64, s64, 1
    s_cmp_le_u32 s64, 2097152
    s_cbranch_scc1 Lp_9
    s_branch Lfin
Ld_10:
    s_mov_b64 exec, -1
Lmlok_8:
    v_and_b32 v56, 0xffff0000, v56
    v_mov_b32 v4, v56
    s_nop 1
    v_max_f32_dpp v4, v4, v4 row_ror:4 row_mask:0xf bank_mask:0xf
    s_nop 1
    v_max_f32_dpp v4, v4, v4 row_ror:8 row_mask:0xf bank_mask:0xf
    v_mov_b32 v5, v4
    s_nop 1
    v_permlane16_swap_b32 v4, v5
    v_max_f32 v4, v4, v5
    v_mov_b32 v5, v4
    s_nop 1
    v_permlane32_swap_b32 v4, v5
    v_max_f32 v4, v4, v5
    v_sub_f32 v4, v56, v4
    v_mul_f32 v4, 0x3fb8aa3b, v4
    v_exp_f32 v4, v4
    s_nop 0
    v_mul_f32 v5, v4, v57
    s_nop 1
    v_add_f32_dpp v5, v5, v5 row_ror:4 row_mask:0xf bank_mask:0xf
    s_nop 1
    v_add_f32_dpp v5, v5, v5 row_ror:8 row_mask:0xf bank_mask:0xf
    v_mov_b32 v6, v5
    s_nop 1
    v_permlane16_swap_b32 v5, v6
    v_add_f32 v5, v5, v6
    v_mov_b32 v6, v5
    s_nop 1
    v_permlane32_swap_b32 v5, v6
    v_add_f32 v5, v5, v6
    v_rcp_f32 v5, v5
    s_mov_b32 s68, 0x000f000f
    s_mov_b32 s69, 0x000f000f
    v_mul_f32 v30, v4, v5
    s_waitcnt vmcnt(0)
    v_xor_b32 v48, s36, v48
    v_xor_b32 v49, s37, v49
    v_xor_b32 v50, s38, v50
    v_xor_b32 v51, s39, v51
    v_or3_b32 v4, v48, v49, v50
    v_or_b32 v4, v51, v4
    v_and_b32 v5, 0xff, v4
    v_cmp_ne_u32 vcc, 0, v5
    s_cbranch_vccz Lopok_11
    s_mov_b32 s64, 0
Lp_12:
    global_load_dwordx4 v[48:51], v33, s[26:27] sc1
    s_waitcnt vmcnt(0)
    v_xor_b32 v48, s36, v48
    v_xor_b32 v49, s37, v49
    v_xor_b32 v50, s38, v50
    v_xor_b32 v51, s39, v51
    v_or3_b32 v4, v48, v49, v50
    v_or_b32 v4, v51, v4
    v_and_b32 v5, 0xff, v4
    v_cmp_ne_u32 vcc, 0, v5
    s_cbranch_vccz Ld_13
    s_nop 0
    s_mov_b64 exec, vcc
    s_add_u32 s64, s64, 1
    s_cmp_le_u32 s64, 2097152
    s_cbranch_scc1 Lp_12
    s_branch Lfin
Ld_13:
    s_mov_b64 exec, -1
Lopok_11:
    v_mul_f32 v48, v48, v30
    v_mul_f32 v49, v49, v30
    v_mul_f32 v50, v50, v30
    v_mul_f32 v51, v51, v30
    v_permlane32_swap_b32 v48, v49
    s_nop 0
    v_permlane32_swap_b32 v50, v51
    v_add_f32 v48, v48, v49
    v_add_f32 v50, v50, v51
    s_nop 1
    v_permlane16_swap_b32 v48, v50
    v_add_f32 v48, v48, v50
    s_nop 1
    v_add_f32_dpp v48, v48, v48 row_ror:4 row_mask:0xf bank_mask:0xf
    s_nop 1
    v_add_f32_dpp v48, v48, v48 row_ror:8 row_mask:0xf bank_mask:0xf
    v_cvt_pk_bf16_f32 v48, v48, v48
    s_mov_b64 exec, s[68:69]
    ds_write_b16 v34, v48 offset:3776
    s_mov_b64 exec, -1
    s_waitcnt lgkmcnt(0)
    s_barrier
    ds_read_b128 v[48:51], v35 offset:3776
    s_waitcnt lgkmcnt(0)
    v_mfma_f32_16x16x32_bf16 v[64:67], v[48:51], v[128:131], 0
    v_mfma_f32_16x16x32_bf16 v[68:71], v[48:51], v[132:135], 0
    v_mfma_f32_16x16x32_bf16 v[72:75], v[48:51], v[136:139], 0
    v_mfma_f32_16x16x32_bf16 v[76:79], v[48:51], v[140:143], 0
    v_mfma_f32_16x16x32_bf16 v[80:83], v[48:51], v[144:147], 0
    v_mfma_f32_16x16x32_bf16 v[84:87], v[48:51], v[148:151], 0
    v_mfma_f32_16x16x32_bf16 v[88:91], v[48:51], v[152:155], 0
    v_mfma_f32_16x16x32_bf16 v[92:95], v[48:51], v[156:159], 0
    s_mov_b64 exec, 0xffff
    s_cmp_eq_u32 s61, 0
    s_cbranch_scc1 Lg_14
    v_bfi_b32 v96, v23, s36, v64
    v_bfi_b32 v97, v23, s37, v65
    v_bfi_b32 v98, v23, s38, v68
    v_bfi_b32 v99, v23, s39, v69
    global_store_dwordx4 v36, v[96:99], s[26:27] offset:0
    v_bfi_b32 v100, v23, s36, v72
    v_bfi_b32 v101, v23, s37, v73
    v_bfi_b32 v102, v23, s38, v76
    v_bfi_b32 v103, v23, s39, v77
    global_store_dwordx4 v36, v[100:103], s[26:27] offset:256
    v_bfi_b32 v104, v23, s36, v80
    v_bfi_b32 v105, v23, s37, v81
    v_bfi_b32 v106, v23, s38, v84
    v_bfi_b32 v107, v23, s39, v85
    global_store_dwordx4 v36, v[104:107], s[26:27] offset:512
    v_bfi_b32 v108, v23, s36, v88
    v_bfi_b32 v109, v23, s37, v89
    v_bfi_b32 v110, v23, s38, v92
    v_bfi_b32 v111, v23, s39, v93
    global_store_dwordx4 v36, v[108:111], s[26:27] offset:768
    s_branch Le_15
Lg_14:
    v_bfi_b32 v96, v23, s36, v64
    v_bfi_b32 v97, v23, s37, v65
    v_bfi_b32 v98, v23, s38, v68
    v_bfi_b32 v99, v23, s39, v69
    global_store_dwordx4 v36, v[96:99], s[26:27] offset:0 sc1
    v_bfi_b32 v100, v23, s36, v72
    v_bfi_b32 v101, v23, s37, v73
    v_bfi_b32 v102, v23, s38, v76
    v_bfi_b32 v103, v23, s39, v77
    global_store_dwordx4 v36, v[100:103], s[26:27] offset:256 sc1
    v_bfi_b32 v104, v23, s36, v80
    v_bfi_b32 v105, v23, s37, v81
    v_bfi_b32 v106, v23, s38, v84
    v_bfi_b32 v107, v23, s39, v85
    global_store_dwordx4 v36, v[104:107], s[26:27] offset:512 sc1
    v_bfi_b32 v108, v23, s36, v88
    v_bfi_b32 v109, v23, s37, v89
    v_bfi_b32 v110, v23, s38, v92
    v_bfi_b32 v111, v23, s39, v93
    global_store_dwordx4 v36, v[108:111], s[26:27] offset:768 sc1
Le_15:
    s_mov_b64 exec, -1
    s_cmp_lg_u32 s32, 0
    s_cbranch_scc1 Lfin
    s_mov_b32 s64, 0
Lp_16:
    global_load_dwordx4 v[48:51], v37, s[26:27] sc1
    global_load_dwordx4 v[52:55], v38, s[26:27] sc1
    global_load_dwordx4 v[56:59], v39, s[26:27] sc1
    global_load_dwordx4 v[60:63], v40, s[26:27] sc1
    s_waitcnt vmcnt(0)
    v_xor_b32 v48, s36, v48
    v_xor_b32 v49, s37, v49
    v_xor_b32 v50, s38, v50
    v_xor_b32 v51, s39, v51
    v_xor_b32 v52, s36, v52
    v_xor_b32 v53, s37, v53
    v_xor_b32 v54, s38, v54
    v_xor_b32 v55, s39, v55
    v_xor_b32 v56, s36, v56
    v_xor_b32 v57, s37, v57
    v_xor_b32 v58, s38, v58
    v_xor_b32 v59, s39, v59
    v_xor_b32 v60, s36, v60
    v_xor_b32 v61, s37, v61
    v_xor_b32 v62, s38, v62
    v_xor_b32 v63, s39, v63
    v_or3_b32 v4, v48, v49, v50
    v_or3_b32 v4, v51, v52, v4
    v_or3_b32 v4, v53, v54, v4
    v_or3_b32 v4, v55, v56, v4
    v_or3_b32 v4, v57, v58, v4
    v_or3_b32 v4, v59, v60, v4
    v_or3_b32 v4, v61, v62, v4
    v_or_b32 v4, v63, v4
    v_and_b32 v5, 0xff, v4
    v_cmp_ne_u32 vcc, 0, v5
    s_cbranch_vccz Ld_17
    s_nop 0
    s_mov_b64 exec, vcc
    s_add_u32 s64, s64, 1
    s_cmp_le_u32 s64, 2097152
    s_cbranch_scc1 Lp_16
    s_branch Lfin
Ld_17:
    s_mov_b64 exec, -1
    v_add_f32 v48, v48, v52
    v_add_f32 v56, v56, v60
    v_add_f32 v49, v49, v53
    v_add_f32 v57, v57, v61
    v_add_f32 v50, v50, v54
    v_add_f32 v58, v58, v62
    v_add_f32 v51, v51, v55
    v_add_f32 v59, v59, v63
    v_add_f32 v48, v48, v56
    v_add_f32 v49, v49, v57
    v_add_f32 v50, v50, v58
    v_add_f32 v51, v51, v59
    v_permlane32_swap_b32 v48, v49
    s_nop 0
    v_permlane32_swap_b32 v50, v51
    v_add_f32 v48, v48, v49
    v_add_f32 v50, v50, v51
    s_nop 1
    v_permlane16_swap_b32 v48, v50
    v_add_f32 v48, v48, v50
    v_mov_b32 v50, v48
    s_nop 1
    v_permlane16_swap_b32 v48, v50
    v_mov_b32 v49, v48
    v_mov_b32 v51, v50
    s_nop 0
    v_permlane32_swap_b32 v48, v49
    v_permlane32_swap_b32 v50, v51
    v_bfi_b32 v52, v23, s36, v48
    v_bfi_b32 v53, v23, s37, v49
    v_bfi_b32 v54, v23, s38, v50
    v_bfi_b32 v55, v23, s39, v51
    global_store_dwordx4 v41, v[52:55], s[26:27] sc1
    global_store_dwordx4 v44, v[52:55], s[26:27] sc1
    s_mov_b32 s64, 0
Lp_18:
    global_load_dwordx4 v[48:51], v42, s[26:27] sc1
    s_waitcnt vmcnt(0)
    v_xor_b32 v48, s36, v48
    v_xor_b32 v49, s37, v49
    v_xor_b32 v50, s38, v50
    v_xor_b32 v51, s39, v51
    v_or3_b32 v4, v48, v49, v50
    v_or_b32 v4, v51, v4
    v_and_b32 v5, 0xff, v4
    v_cmp_ne_u32 vcc, 0, v5
    s_cbranch_vccz Ld_19
    s_nop 0
    s_mov_b64 exec, vcc
    s_add_u32 s64, s64, 1
    s_cmp_le_u32 s64, 2097152
    s_cbranch_scc1 Lp_18
    s_branch Lfin
Ld_19:
    s_mov_b64 exec, -1
    v_add_f32_dpp v48, v48, v48 quad_perm:[2,3,0,1] row_mask:0xf bank_mask:0xf
    v_add_f32_dpp v49, v49, v49 quad_perm:[2,3,0,1] row_mask:0xf bank_mask:0xf
    v_add_f32_dpp v50, v50, v50 quad_perm:[2,3,0,1] row_mask:0xf bank_mask:0xf
    v_add_f32_dpp v51, v51, v51 quad_perm:[2,3,0,1] row_mask:0xf bank_mask:0xf
    v_add_f32_dpp v48, v48, v48 row_ror:4 row_mask:0xf bank_mask:0xf
    v_add_f32_dpp v49, v49, v49 row_ror:4 row_mask:0xf bank_mask:0xf
    v_add_f32_dpp v50, v50, v50 row_ror:4 row_mask:0xf bank_mask:0xf
    v_add_f32_dpp v51, v51, v51 row_ror:4 row_mask:0xf bank_mask:0xf
    v_add_f32_dpp v48, v48, v48 row_ror:8 row_mask:0xf bank_mask:0xf
    v_add_f32_dpp v49, v49, v49 row_ror:8 row_mask:0xf bank_mask:0xf
    v_add_f32_dpp v50, v50, v50 row_ror:8 row_mask:0xf bank_mask:0xf
    v_add_f32_dpp v51, v51, v51 row_ror:8 row_mask:0xf bank_mask:0xf
    s_nop 0
    v_mov_b32_dpp v48, v50 quad_perm:[0,1,2,3] row_mask:0x2 bank_mask:0xf
    s_nop 1
    v_mov_b32_dpp v48, v49 quad_perm:[0,1,2,3] row_mask:0x4 bank_mask:0xf
    s_nop 1
    v_mov_b32_dpp v48, v51 quad_perm:[0,1,2,3] row_mask:0x8 bank_mask:0xf
    v_lshlrev_b32 v52, 16, v234
    v_add_f32 v48, v48, v52
    s_mov_b32 s68, 0x00030003
    s_mov_b32 s69, 0x00030003
    v_cvt_pk_bf16_f32 v216, v48, v48
    v_and_b32 v216, 0xffff0000, v216
    s_mov_b32 s64, 0
Lp_20:
    global_load_dwordx4 v[48:51], v45, s[26:27] sc1
    s_waitcnt vmcnt(0)
    v_xor_b32 v48, s36, v48
    v_xor_b32 v49, s37, v49
    v_xor_b32 v50, s38, v50
    v_xor_b32 v51, s39, v51
    v_or3_b32 v4, v48, v49, v50
    v_or_b32 v4, v51, v4
    v_and_b32 v5, 0xff, v4
    v_cmp_ne_u32 vcc, 0, v5
    s_cbranch_vccz Ld_21
    s_nop 0
    s_mov_b64 exec, vcc
    s_add_u32 s64, s64, 1
    s_cmp_le_u32 s64, 2097152
    s_cbranch_scc1 Lp_20
    s_branch Lfin
Ld_21:
    s_mov_b64 exec, -1
    v_mul_f32 v48, v48, v244
    v_mul_f32 v49, v49, v244
    v_mul_f32 v50, v50, v244
    v_mul_f32 v51, v51, v244
    v_permlane32_swap_b32 v48, v49
    s_nop 0
    v_permlane32_swap_b32 v50, v51
    v_add_f32 v48, v48, v49
    v_add_f32 v50, v50, v51
    s_nop 1
    v_permlane16_swap_b32 v48, v50
    v_add_f32 v48, v48, v50
    s_nop 1
    v_add_f32_dpp v48, v48, v48 quad_perm:[2,3,0,1] row_mask:0xf bank_mask:0xf
    s_nop 1
    v_add_f32_dpp v48, v48, v48 row_ror:4 row_mask:0xf bank_mask:0xf
    s_nop 1
    v_add_f32_dpp v48, v48, v48 row_ror:8 row_mask:0xf bank_mask:0xf
    v_add_f32 v48, v48, v216
    v_cvt_pk_bf16_f32 v52, v48, v48
    s_mov_b64 exec, s[68:69]
    global_store_short v245, v52, s[22:23]
    s_cmp_lg_u32 s2, 0
    s_cbranch_scc1 Lfin
    s_mov_b64 exec, 1
    v_mov_b32 v8, 0
    v_mov_b32 v9, s60
    global_store_dword v8, v9, s[26:27] sc1
    s_branch Lfin
LroleF:
    s_sub_u32 s69, s29, 16
    s_lshr_b32 s24, s69, 2
    s_and_b32 s25, s69, 3
    s_cmp_lt_u32 s28, 4
    s_cselect_b32 s33, 4, 3
    s_cmp_ge_u32 s24, s33
    s_cbranch_scc1 Lidle_22
    s_lshl_b32 s33, s28, 2
    s_mul_i32 s68, s28, 3
    s_add_u32 s68, s68, 4
    s_cmp_lt_u32 s28, 4
    s_cselect_b32 s15, s33, s68
    s_add_u32 s15, s15, s24
    s_lshr_b32 s33, s32, 1
    s_cmp_eq_u32 s33, 0
    s_cselect_b32 s56, s16, s18
    s_cselect_b32 s57, s17, s19
    s_lshl_b32 s33, s25, 1
    s_and_b32 s68, s32, 1
    s_add_u32 s33, s33, s68
    s_mul_i32 s33, s33, 229376
    s_lshl_b32 s68, s15, 7
    s_add_u32 s33, s33, s68
    s_add_u32 s56, s56, s33
    s_addc_u32 s57, s57, 0
    s_and_b32 s57, s57, 0xffff
    s_mov_b32 s58, 229376
    s_mov_b32 s59, 0x20000
    v_lshrrev_b32 v9, 3, v1
    v_mul_u32_u24 v9, 3584, v9
    v_and_b32 v10, 7, v1
    v_lshl_add_u32 v247, v10, 4, v9
    s_lshl_b32 s33, s32, 13
    s_add_u32 s14, s33, 24576
    s_lshl_b32 s33, s15, 2
    s_add_u32 s33, s33, s32
    s_lshl_b32 s33, s33, 4
    v_lshl_add_u32 v11, v3, 2, s33
    v_lshlrev_b32 v11, 10, v11
    v_lshl_add_u32 v11, v2, 4, v11
    s_lshl_b32 s33, s25, 8
    v_add_u32 v246, s33, v11
    s_lshl_b32 s33, s15, 9
    s_lshl_b32 s68, s25, 7
    s_add_u32 s33, s33, s68
    s_add_u32 s33, s33, 1638400
    v_lshrrev_b32 v11, 3, v1
    v_mul_u32_u24 v11, 14336, v11
    v_and_b32 v12, 7, v1
    v_lshl_add_u32 v11, v12, 4, v11
    v_add_u32 v47, s33, v11
    v_mov_b32 v4, 0x3f803f80
    v_lshlrev_b32 v5, 2, v1
    ds_write_b32 v5, v4 offset:6400
    s_lshl_b32 s33, s28, 15
    s_add_u32 s33, s33, 2162688
    s_lshl_b32 s68, s25, 10
    s_add_u32 s33, s33, s68
    s_lshl_b32 s68, s32, 8
    s_add_u32 s33, s33, s68
    v_lshl_add_u32 v32, v2, 4, s33
    v_lshl_add_u32 v32, v3, 12, v32
    v_add_u32 v42, 16384, v32
    s_lshl_b32 s33, s25, 8
    s_lshl_b32 s68, s32, 2
    s_add_u32 s33, s33, s68
    v_lshl_add_u32 v10, v2, 4, s33
    v_and_b32 v11, 1, v3
    v_lshl_add_u32 v10, v11, 1, v10
    v_lshrrev_b32 v11, 1, v3
    v_lshl_add_u32 v10, v11, 10, v10
    global_load_ushort v234, v10, s[4:5]
    v_lshrrev_b32 v10, 2, v2
    v_lshlrev_b32 v10, 6, v10
    v_and_b32 v11, 1, v2
    v_lshl_add_u32 v10, v11, 5, v10
    v_bfe_u32 v11, v2, 1, 1
    v_lshl_add_u32 v10, v11, 3, v10
    v_and_b32 v11, 1, v3
    v_lshl_add_u32 v10, v11, 1, v10
    v_lshrrev_b32 v11, 1, v3
    v_mul_u32_u24 v11, 288, v11
    v_add_u32 v10, v10, v11
    s_lshr_b32 s33, s32, 1
    s_lshl_b32 s33, s33, 4
    s_and_b32 s68, s32, 1
    s_lshl_b32 s68, s68, 2
    s_add_u32 s33, s33, s68
    s_add_u32 s33, s33, 4096
    v_add_u32 v33, s33, v10
    v_mul_u32_u24 v10, 288, v2
    v_add_u32 v10, 4096, v10
    v_mov_b32 v11, 6400
    v_cmp_gt_u32 vcc, 2, v2
    s_nop 1
    v_cndmask_b32 v10, v11, v10, vcc
    v_lshl_add_u32 v35, v3, 4, v10
    v_bfe_u32 v10, v2, 2, 1
    v_and_b32 v11, 3, v2
    v_lshlrev_b32 v11, 3, v11
    v_lshl_add_u32 v11, v10, 5, v11
    v_lshrrev_b32 v12, 1, v3
    v_and_b32 v13, 1, v3
    v_lshl_add_u32 v12, v13, 1, v12
    v_lshl_add_u32 v37, v12, 1, v11
    s_lshl_b32 s33, s32, 6
    v_add_u32 v37, s33, v37
    v_and_b32 v11, 1, v2
    v_lshlrev_b32 v11, 5, v11
    v_lshl_add_u32 v38, v3, 3, v11
    v_add_u32 v38, s33, v38
    v_lshrrev_b32 v10, 2, v1
    v_lshlrev_b32 v10, 7, v10
    v_and_b32 v11, 3, v1
    v_lshl_add_u32 v10, v11, 3, v10
    s_lshl_b32 s33, s32, 5
    s_add_u32 s33, s33, 24576
    v_add_u32 v40, s33, v10
    s_lshl_b32 s33, s32, 10
    s_add_u32 s33, s33, 16384
    v_lshl_add_u32 v41, v2, 4, s33
    v_add_u32 v36, 16384, v20
    s_lshl_b32 s33, s28, 15
    s_lshl_b32 s68, s24, 13
    s_add_u32 s33, s33, s68
    s_add_u32 s33, s33, 1310720
    s_lshl_b32 s68, s32, 11
    s_add_u32 s68, s68, s33
    s_lshl_b32 s15, s25, 9
    s_add_u32 s68, s68, s15
    v_lshl_add_u32 v10, v2, 2, v3
    v_lshl_add_u32 v43, v10, 4, s68
    v_add_u32 v10, 12, v2
    v_lshl_add_u32 v45, v10, 4, s68
    s_lshl_b32 s68, s32, 11
    s_add_u32 s33, s33, s68
    v_min_u32 v10, 14, v2
    v_lshlrev_b32 v10, 4, v10
    v_lshl_add_u32 v10, v3, 9, v10
    v_add_u32 v44, s33, v10
    v_min_u32 v11, 11, v2
    v_lshlrev_b32 v11, 4, v11
    v_lshl_add_u32 v11, v3, 9, v11
    v_add_u32 v46, s33, v11
    v_lshrrev_b32 v11, 1, v1
    s_lshl_b32 s33, s32, 2
    v_add_u32 v11, s33, v11
    v_and_b32 v10, 1, v1
    v_lshlrev_b32 v10, 7, v10
    v_lshl_add_u32 v10, v11, 12, v10
    s_lshl_b32 s33, s28, 16
    s_sub_u32 s68, s29, 16
    s_lshl_b32 s68, s68, 8
    s_add_u32 s33, s33, s68
    s_add_u32 s33, s33, 786432
    v_add_u32 v9, s33, v10
    s_mov_b64 exec, 0xff
    global_load_dword v236, v9, s[26:27]
    s_mov_b64 exec, -1
    s_waitcnt vmcnt(10)
    v_perm_b32 v128, v68, v64, s65
    v_perm_b32 v132, v68, v64, s66
    v_perm_b32 v136, v69, v65, s65
    v_perm_b32 v140, v69, v65, s66
    v_perm_b32 v144, v70, v66, s65
    v_perm_b32 v148, v70, v66, s66
    v_perm_b32 v152, v71, v67, s65
    v_perm_b32 v156, v71, v67, s66
    v_perm_b32 v129, v76, v72, s65
    v_perm_b32 v133, v76, v72, s66
    v_perm_b32 v137, v77, v73, s65
    v_perm_b32 v141, v77, v73, s66
    v_perm_b32 v145, v78, v74, s65
    v_perm_b32 v149, v78, v74, s66
    v_perm_b32 v153, v79, v75, s65
    v_perm_b32 v157, v79, v75, s66
    v_perm_b32 v130, v84, v80, s65
    v_perm_b32 v134, v84, v80, s66
    v_perm_b32 v138, v85, v81, s65
    v_perm_b32 v142, v85, v81, s66
    v_perm_b32 v146, v86, v82, s65
    v_perm_b32 v150, v86, v82, s66
    v_perm_b32 v154, v87, v83, s65
    v_perm_b32 v158, v87, v83, s66
    v_perm_b32 v131, v92, v88, s65
    v_perm_b32 v135, v92, v88, s66
    v_perm_b32 v139, v93, v89, s65
    v_perm_b32 v143, v93, v89, s66
    v_perm_b32 v147, v94, v90, s65
    v_perm_b32 v151, v94, v90, s66
    v_perm_b32 v155, v95, v91, s65
    v_perm_b32 v159, v95, v91, s66
    v_mfma_f32_16x16x32_bf16 a[80:83], v[128:131], v[208:211], 0
    v_mfma_f32_16x16x32_bf16 a[84:87], v[132:135], v[208:211], 0
    v_mfma_f32_16x16x32_bf16 a[88:91], v[136:139], v[208:211], 0
    v_mfma_f32_16x16x32_bf16 a[92:95], v[140:143], v[208:211], 0
    v_mfma_f32_16x16x32_bf16 a[96:99], v[144:147], v[208:211], 0
    v_mfma_f32_16x16x32_bf16 a[100:103], v[148:151], v[208:211], 0
    v_mfma_f32_16x16x32_bf16 a[104:107], v[152:155], v[208:211], 0
    v_mfma_f32_16x16x32_bf16 a[108:111], v[156:159], v[208:211], 0
    s_waitcnt vmcnt(8)
    v_perm_b32 v128, v100, v96, s65
    v_perm_b32 v132, v100, v96, s66
    v_perm_b32 v136, v101, v97, s65
    v_perm_b32 v140, v101, v97, s66
    v_perm_b32 v144, v102, v98, s65
    v_perm_b32 v148, v102, v98, s66
    v_perm_b32 v152, v103, v99, s65
    v_perm_b32 v156, v103, v99, s66
    s_waitcnt vmcnt(6)
    v_perm_b32 v129, v108, v104, s65
    v_perm_b32 v133, v108, v104, s66
    v_perm_b32 v137, v109, v105, s65
    v_perm_b32 v141, v109, v105, s66
    v_perm_b32 v145, v110, v106, s65
    v_perm_b32 v149, v110, v106, s66
    v_perm_b32 v153, v111, v107, s65
    v_perm_b32 v157, v111, v107, s66
    s_waitcnt vmcnt(4)
    v_perm_b32 v130, v116, v112, s65
    v_perm_b32 v134, v116, v112, s66
    v_perm_b32 v138, v117, v113, s65
    v_perm_b32 v142, v117, v113, s66
    v_perm_b32 v146, v118, v114, s65
    v_perm_b32 v150, v118, v114, s66
    v_perm_b32 v154, v119, v115, s65
    v_perm_b32 v158, v119, v115, s66
    s_waitcnt vmcnt(2)
    v_perm_b32 v131, v124, v120, s65
    v_perm_b32 v135, v124, v120, s66
    v_perm_b32 v139, v125, v121, s65
    v_perm_b32 v143, v125, v121, s66
    v_perm_b32 v147, v126, v122, s65
    v_perm_b32 v151, v126, v122, s66
    v_perm_b32 v155, v127, v123, s65
    v_perm_b32 v159, v127, v123, s66
    v_mfma_f32_16x16x32_bf16 a[80:83], v[128:131], v[212:215], a[80:83]
    v_mfma_f32_16x16x32_bf16 a[84:87], v[132:135], v[212:215], a[84:87]
    v_mfma_f32_16x16x32_bf16 a[88:91], v[136:139], v[212:215], a[88:91]
    v_mfma_f32_16x16x32_bf16 a[92:95], v[140:143], v[212:215], a[92:95]
    v_mfma_f32_16x16x32_bf16 a[96:99], v[144:147], v[212:215], a[96:99]
    v_mfma_f32_16x16x32_bf16 a[100:103], v[148:151], v[212:215], a[100:103]
    v_mfma_f32_16x16x32_bf16 a[104:107], v[152:155], v[212:215], a[104:107]
    v_mfma_f32_16x16x32_bf16 a[108:111], v[156:159], v[212:215], a[108:111]
    s_mov_b32 s68, 0x000f000f
    s_mov_b32 s69, 0x000f000f
    s_mov_b64 exec, s[68:69]
    ds_write_b128 v224, a[80:83]
    ds_write_b128 v225, a[84:87]
    ds_write_b128 v226, a[88:91]
    ds_write_b128 v227, a[92:95]
    ds_write_b128 v228, a[96:99]
    ds_write_b128 v229, a[100:103]
    ds_write_b128 v230, a[104:107]
    ds_write_b128 v231, a[108:111]
    s_mov_b64 exec, -1
    s_waitcnt lgkmcnt(0)
    s_barrier
    s_cmp_ge_u32 s32, 2
    s_cbranch_scc1 Lopskip_23
    ds_read_b128 v[192:195], v232 offset:8192
    ds_read_b128 v[196:199], v232 offset:10240
    ds_read_b128 v[200:203], v232 offset:12288
    ds_read_b128 v[204:207], v232 offset:14336
    s_waitcnt lgkmcnt(0)
    v_add_f32 v192, v192, v196
    v_add_f32 v200, v200, v204
    v_add_f32 v193, v193, v197
    v_add_f32 v201, v201, v205
    v_add_f32 v194, v194, v198
    v_add_f32 v202, v202, v206
    v_add_f32 v195, v195, v199
    v_add_f32 v203, v203, v207
    v_add_f32 v192, v192, v200
    v_add_f32 v193, v193, v201
    v_add_f32 v194, v194, v202
    v_add_f32 v195, v195, v203
    v_bfi_b32 v196, v23, s36, v192
    v_bfi_b32 v197, v23, s37, v193
    v_bfi_b32 v198, v23, s38, v194
    v_bfi_b32 v199, v23, s39, v195
    s_cmp_eq_u32 s61, 0
    s_cbranch_scc1 Lg_24
    global_store_dwordx4 v233, v[196:199], s[26:27]
    s_branch Le_25
Lg_24:
    global_store_dwordx4 v233, v[196:199], s[26:27] sc1
Le_25:
Lopskip_23:
    s_waitcnt vmcnt(1)
    v_lshlrev_b32 v60, 16, v234
    s_lshl_b32 s15, s28, 15
    s_add_u32 s15, s15, 2162688
    s_sub_u32 s69, s29, 16
    s_and_b32 s25, s69, 3
    v_lshrrev_b32 v10, 3, v1
    s_lshl_b32 s33, s32, 1
    v_add_u32 v10, s33, v10
    v_lshlrev_b32 v10, 12, v10
    v_and_b32 v11, 7, v1
    v_lshl_add_u32 v10, v11, 7, v10
    s_lshl_b32 s33, s25, 10
    s_add_u32 s33, s33, s15
    v_add_u32 v9, s33, v10
    s_lshr_b32 s68, s69, 2
    s_lshl_b32 s68, s68, 13
    s_lshl_b32 s33, s28, 15
    s_add_u32 s33, s33, s68
    s_lshl_b32 s68, s32, 11
    s_add_u32 s33, s33, s68
    s_add_u32 s33, s33, 1310720
    v_subrev_u32 v10, 16, v1
    v_lshl_add_u32 v12, v10, 7, s33
    v_cmp_gt_u32 vcc, 16, v1
    s_nop 1
    v_cndmask_b32 v9, v12, v9, vcc
    s_mov_b32 exec_hi, 0
    global_load_dword v237, v9, s[26:27]
    s_mov_b64 exec, -1
    s_add_u32 m0, s14, 0
    s_mov_b32 s33, 0
    buffer_load_dwordx4 v247, s[56:59], s33 offen nt lds
    s_add_u32 m0, s14, 1024
    s_mov_b32 s33, 28672
    buffer_load_dwordx4 v247, s[56:59], s33 offen nt lds
    s_add_u32 m0, s14, 2048
    s_mov_b32 s33, 57344
    buffer_load_dwordx4 v247, s[56:59], s33 offen nt lds
    s_add_u32 m0, s14, 3072
    s_mov_b32 s33, 86016
    buffer_load_dwordx4 v247, s[56:59], s33 offen nt lds
    s_add_u32 m0, s14, 4096
    s_mov_b32 s33, 114688
    buffer_load_dwordx4 v247, s[56:59], s33 offen nt lds
    s_add_u32 m0, s14, 5120
    s_mov_b32 s33, 143360
    buffer_load_dwordx4 v247, s[56:59], s33 offen nt lds
    s_add_u32 m0, s14, 6144
    s_mov_b32 s33, 172032
    buffer_load_dwordx4 v247, s[56:59], s33 offen nt lds
    s_add_u32 m0, s14, 7168
    s_mov_b32 s33, 200704
    buffer_load_dwordx4 v247, s[56:59], s33 offen nt lds
    global_load_dwordx4 v[160:163], v246, s[20:21] offset:0 nt
    global_load_dwordx4 v[164:167], v246, s[20:21] offset:1024 nt
    global_load_dwordx4 v[168:171], v246, s[20:21] offset:2048 nt
    global_load_dwordx4 v[172:175], v246, s[20:21] offset:3072 nt
    s_waitcnt vmcnt(4)
    s_waitcnt lgkmcnt(0)
    s_barrier
    ds_read_b64_tr_b16 a[0:1], v40 offset:0
    ds_read_b64_tr_b16 a[2:3], v40 offset:2048
    ds_read_b64_tr_b16 a[4:5], v40 offset:4096
    ds_read_b64_tr_b16 a[6:7], v40 offset:6144
    ds_read_b64_tr_b16 a[8:9], v40 offset:8192
    ds_read_b64_tr_b16 a[10:11], v40 offset:10240
    ds_read_b64_tr_b16 a[12:13], v40 offset:12288
    ds_read_b64_tr_b16 a[14:15], v40 offset:14336
    ds_read_b64_tr_b16 a[16:17], v40 offset:16384
    ds_read_b64_tr_b16 a[18:19], v40 offset:18432
    ds_read_b64_tr_b16 a[20:21], v40 offset:20480
    ds_read_b64_tr_b16 a[22:23], v40 offset:22528
    ds_read_b64_tr_b16 a[24:25], v40 offset:24576
    ds_read_b64_tr_b16 a[26:27], v40 offset:26624
    ds_read_b64_tr_b16 a[28:29], v40 offset:28672
    ds_read_b64_tr_b16 a[30:31], v40 offset:30720
    s_waitcnt vmcnt(0)
    v_perm_b32 v128, v164, v160, s65
    v_perm_b32 v129, v172, v168, s65
    v_perm_b32 v130, v164, v160, s66
    v_perm_b32 v131, v172, v168, s66
    v_perm_b32 v132, v165, v161, s65
    v_perm_b32 v133, v173, v169, s65
    v_perm_b32 v134, v165, v161, s66
    v_perm_b32 v135, v173, v169, s66
    v_perm_b32 v136, v166, v162, s65
    v_perm_b32 v137, v174, v170, s65
    v_perm_b32 v138, v166, v162, s66
    v_perm_b32 v139, v174, v170, s66
    v_perm_b32 v140, v167, v163, s65
    v_perm_b32 v141, v175, v171, s65
    v_perm_b32 v142, v167, v163, s66
    v_perm_b32 v143, v175, v171, s66
    s_mov_b32 s68, 0x00070007
    s_mov_b32 s69, 0x00070007
    s_waitcnt lgkmcnt(0)
    s_mov_b32 s68, 0x00070007
    s_mov_b32 s69, 0x00070007
    s_mov_b32 s64, 0
Lp_26:
    global_load_dwordx4 v[48:51], v32, s[26:27] sc1
    global_load_dwordx4 v[52:55], v42, s[26:27] sc1
    s_waitcnt vmcnt(0)
    v_xor_b32 v48, s36, v48
    v_xor_b32 v49, s37, v49
    v_xor_b32 v50, s38, v50
    v_xor_b32 v51, s39, v51
    v_xor_b32 v52, s36, v52
    v_xor_b32 v53, s37, v53
    v_xor_b32 v54, s38, v54
    v_xor_b32 v55, s39, v55
    v_or3_b32 v4, v48, v49, v50
    v_or3_b32 v4, v51, v52, v4
    v_or3_b32 v4, v53, v54, v4
    v_or_b32 v4, v55, v4
    v_and_b32 v5, 0xff, v4
    v_cmp_ne_u32 vcc, 0, v5
    s_cbranch_vccz Ld_27
    s_nop 0
    s_mov_b64 exec, vcc
    s_add_u32 s64, s64, 1
    s_cmp_le_u32 s64, 2097152
    s_cbranch_scc1 Lp_26
    s_branch Lfin
Ld_27:
    s_mov_b64 exec, -1
    v_add_f32 v48, v48, v52
    v_add_f32 v49, v49, v53
    v_add_f32 v50, v50, v54
    v_add_f32 v51, v51, v55
    v_permlane32_swap_b32 v48, v49
    s_nop 0
    v_permlane32_swap_b32 v50, v51
    v_add_f32 v48, v48, v49
    v_add_f32 v50, v50, v51
    s_nop 1
    v_permlane16_swap_b32 v48, v50
    v_add_f32 v48, v48, v50
    v_add_f32 v48, v48, v60
    v_cvt_pk_bf16_f32 v48, v48, v48
    ds_write_b16 v33, v48
    s_waitcnt lgkmcnt(0)
    s_barrier
    ds_read_b128 a[64:67], v35 offset:0
    ds_read_b128 a[68:71], v35 offset:64
    ds_read_b128 a[72:75], v35 offset:128
    ds_read_b128 a[76:79], v35 offset:192
    s_waitcnt lgkmcnt(3)
    v_mfma_f32_16x16x32_bf16 v[208:211], a[0:3], a[64:67], 0
    v_mfma_f32_16x16x32_bf16 v[212:215], a[16:19], a[64:67], 0
    v_mfma_f32_16x16x32_bf16 v[224:227], a[64:67], a[64:67], 0
    s_waitcnt lgkmcnt(2)
    v_mfma_f32_16x16x32_bf16 v[208:211], a[4:7], a[68:71], v[208:211]
    v_mfma_f32_16x16x32_bf16 v[212:215], a[20:23], a[68:71], v[212:215]
    v_mfma_f32_16x16x32_bf16 v[224:227], a[68:71], a[68:71], v[224:227]
    s_waitcnt lgkmcnt(1)
    v_mfma_f32_16x16x32_bf16 v[208:211], a[8:11], a[72:75], v[208:211]
    v_mfma_f32_16x16x32_bf16 v[212:215], a[24:27], a[72:75], v[212:215]
    v_mfma_f32_16x16x32_bf16 v[224:227], a[72:75], a[72:75], v[224:227]
    s_waitcnt lgkmcnt(0)
    v_mfma_f32_16x16x32_bf16 v[208:211], a[12:15], a[76:79], v[208:211]
    v_mfma_f32_16x16x32_bf16 v[212:215], a[28:31], a[76:79], v[212:215]
    v_mfma_f32_16x16x32_bf16 v[224:227], a[76:79], a[76:79], v[224:227]
    s_mov_b64 exec, s[68:69]
    s_cmp_eq_u32 s61, 0
    s_cbranch_scc1 Lg_28
    s_nop 2
    v_bfi_b32 v216, v23, s36, v208
    v_bfi_b32 v217, v23, s37, v209
    v_bfi_b32 v218, v23, s38, v210
    v_bfi_b32 v219, v23, s39, v211
    global_store_dwordx4 v43, v[216:219], s[26:27]
    v_bfi_b32 v220, v23, s36, v212
    v_bfi_b32 v221, v23, s37, v213
    v_bfi_b32 v222, v23, s38, v214
    v_bfi_b32 v223, v23, s39, v215
    global_store_dwordx4 v43, v[220:223], s[26:27] offset:256
    s_mov_b64 exec, 7
    v_bfi_b32 v228, v23, s36, v224
    v_bfi_b32 v229, v23, s37, v225
    v_bfi_b32 v230, v23, s38, v226
    v_bfi_b32 v231, v23, s39, v227
    global_store_dwordx4 v45, v[228:231], s[26:27]
    s_branch Le_29
Lg_28:
    s_nop 2
    v_bfi_b32 v216, v23, s36, v208
    v_bfi_b32 v217, v23, s37, v209
    v_bfi_b32 v218, v23, s38, v210
    v_bfi_b32 v219, v23, s39, v211
    global_store_dwordx4 v43, v[216:219], s[26:27] sc1
    v_bfi_b32 v220, v23, s36, v212
    v_bfi_b32 v221, v23, s37, v213
    v_bfi_b32 v222, v23, s38, v214
    v_bfi_b32 v223, v23, s39, v215
    global_store_dwordx4 v43, v[220:223], s[26:27] offset:256 sc1
    s_mov_b64 exec, 7
    v_bfi_b32 v228, v23, s36, v224
    v_bfi_b32 v229, v23, s37, v225
    v_bfi_b32 v230, v23, s38, v226
    v_bfi_b32 v231, v23, s39, v227
    global_store_dwordx4 v45, v[228:231], s[26:27] sc1
Le_29:
    s_mov_b64 exec, -1
    s_mov_b32 s68, 0x00ff00ff
    s_mov_b32 s69, 0x00ff00ff
    v_bfe_u32 v10, v2, 2, 1
    v_cmp_eq_u32 s[24:25], 1, v10
    s_mov_b32 s64, 0
Lp_30:
    global_load_dwordx4 v[48:51], v44, s[26:27] sc1
    global_load_dwordx4 v[52:55], v46, s[26:27] offset:256 sc1
    s_waitcnt vmcnt(0)
    v_xor_b32 v48, s36, v48
    v_xor_b32 v49, s37, v49
    v_xor_b32 v50, s38, v50
    v_xor_b32 v51, s39, v51
    v_xor_b32 v52, s36, v52
    v_xor_b32 v53, s37, v53
    v_xor_b32 v54, s38, v54
    v_xor_b32 v55, s39, v55
    v_or3_b32 v4, v48, v49, v50
    v_or3_b32 v4, v51, v52, v4
    v_or3_b32 v4, v53, v54, v4
    v_or_b32 v4, v55, v4
    v_and_b32 v5, 0xff, v4
    v_cmp_ne_u32 vcc, 0, v5
    s_cbranch_vccz Ld_31
    s_nop 0
    s_mov_b64 exec, vcc
    s_add_u32 s64, s64, 1
    s_cmp_le_u32 s64, 2097152
    s_cbranch_scc1 Lp_30
    s_branch Lfin
Ld_31:
    s_mov_b64 exec, -1
    v_permlane32_swap_b32 v48, v49
    v_permlane32_swap_b32 v50, v51
    v_permlane32_swap_b32 v52, v53
    v_permlane32_swap_b32 v54, v55
    v_add_f32 v48, v48, v49
    v_add_f32 v50, v50, v51
    v_add_f32 v52, v52, v53
    v_add_f32 v54, v54, v55
    v_permlane16_swap_b32 v48, v50
    s_nop 0
    v_permlane16_swap_b32 v52, v54
    v_add_f32 v48, v48, v50
    v_add_f32 v52, v52, v54
    v_readlane_b32 s33, v48, 14
    v_readlane_b32 s15, v48, 12
    v_readlane_b32 s14, v48, 46
    v_readlane_b32 s64, v48, 45
    v_mov_b32_dpp v49, v48 row_shl:8 row_mask:0xf bank_mask:0x1
    v_mov_b32_dpp v53, v52 row_shl:8 row_mask:0xf bank_mask:0x1
    s_nop 0
    v_mov_b32_dpp v49, v48 row_shl:4 row_mask:0xf bank_mask:0x2
    v_mov_b32_dpp v53, v52 row_shl:4 row_mask:0xf bank_mask:0x2
    v_mov_b32 v30, s33
    v_mov_b32 v56, s14
    v_mov_b32 v31, s15
    v_mov_b32 v57, s64
    v_cndmask_b32 v30, v30, v56, s[24:25]
    v_cndmask_b32 v31, v31, v57, s[24:25]
    v_mul_f32 v30, 0x3b000000, v30
    v_mul_f32 v31, 0x3b000000, v31
    v_fma_f32 v31, -v30, v30, v31
    v_max_f32 v31, 0, v31
    v_add_f32 v31, 0x3727c5ac, v31
    v_rsq_f32 v31, v31
    v_fma_f32 v48, -v30, v49, v48
    v_fma_f32 v52, -v30, v53, v52
    v_mul_f32 v48, v48, v31
    v_mul_f32 v52, v52, v31
    v_mul_f32 v49, 0xbfb8aa3b, v48
    v_exp_f32 v49, v49
    v_mul_f32 v48, v48, v52
    v_add_f32 v49, 1.0, v49
    v_rcp_f32 v49, v49
    s_nop 0
    v_mul_f32 v48, v48, v49
    v_cvt_pk_bf16_f32 v48, v48, v48
    s_mov_b64 exec, s[68:69]
    ds_write_b16 v37, v48 offset:6720
    s_mov_b64 exec, -1
    ds_read_b64 v[224:225], v38 offset:6720
    s_waitcnt lgkmcnt(0)
    v_mfma_f32_16x16x16_bf16 v[64:67], v[224:225], v[128:129], 0
    v_mfma_f32_16x16x16_bf16 v[68:71], v[224:225], v[130:131], 0
    v_mfma_f32_16x16x16_bf16 v[72:75], v[224:225], v[132:133], 0
    v_mfma_f32_16x16x16_bf16 v[76:79], v[224:225], v[134:135], 0
    v_mfma_f32_16x16x16_bf16 v[80:83], v[224:225], v[136:137], 0
    v_mfma_f32_16x16x16_bf16 v[84:87], v[224:225], v[138:139], 0
    v_mfma_f32_16x16x16_bf16 v[88:91], v[224:225], v[140:141], 0
    v_mfma_f32_16x16x16_bf16 v[92:95], v[224:225], v[142:143], 0
    s_mov_b64 exec, 0xffff
    ds_write_b64 v41, v[64:65] offset:0
    ds_write_b64 v41, v[68:69] offset:8
    ds_write_b64 v41, v[72:73] offset:256
    ds_write_b64 v41, v[76:77] offset:264
    ds_write_b64 v41, v[80:81] offset:512
    ds_write_b64 v41, v[84:85] offset:520
    ds_write_b64 v41, v[88:89] offset:768
    ds_write_b64 v41, v[92:93] offset:776
    s_mov_b64 exec, -1
    s_waitcnt lgkmcnt(0)
    s_barrier
    s_cmp_lg_u32 s32, 0
    s_cbranch_scc1 Lfin
    ds_read_b128 v[192:195], v36 offset:0
    ds_read_b128 v[196:199], v36 offset:1024
    ds_read_b128 v[200:203], v36 offset:2048
    ds_read_b128 v[204:207], v36 offset:3072
    s_waitcnt lgkmcnt(0)
    v_add_f32 v192, v192, v196
    v_add_f32 v200, v200, v204
    v_add_f32 v193, v193, v197
    v_add_f32 v201, v201, v205
    v_add_f32 v194, v194, v198
    v_add_f32 v202, v202, v206
    v_add_f32 v195, v195, v199
    v_add_f32 v203, v203, v207
    v_add_f32 v192, v192, v200
    v_add_f32 v193, v193, v201
    v_add_f32 v194, v194, v202
    v_add_f32 v195, v195, v203
    v_bfi_b32 v196, v23, s36, v192
    v_bfi_b32 v197, v23, s37, v193
    v_bfi_b32 v198, v23, s38, v194
    v_bfi_b32 v199, v23, s39, v195
    global_store_dwordx4 v47, v[196:199], s[26:27] sc1
    s_branch Lfin
Lidle_22:
    v_lshrrev_b32 v11, 1, v1
    s_lshl_b32 s33, s32, 2
    v_add_u32 v11, s33, v11
    v_and_b32 v10, 1, v1
    v_lshlrev_b32 v10, 7, v10
    v_lshl_add_u32 v10, v11, 12, v10
    s_lshl_b32 s33, s28, 16
    s_sub_u32 s68, s29, 16
    s_lshl_b32 s68, s68, 8
    s_add_u32 s33, s33, s68
    s_add_u32 s33, s33, 786432
    v_add_u32 v9, s33, v10
    s_mov_b64 exec, 0xff
    global_load_dword v236, v9, s[26:27]
    s_mov_b64 exec, -1
    s_waitcnt vmcnt(9)
    v_perm_b32 v128, v68, v64, s65
    v_perm_b32 v132, v68, v64, s66
    v_perm_b32 v136, v69, v65, s65
    v_perm_b32 v140, v69, v65, s66
    v_perm_b32 v144, v70, v66, s65
    v_perm_b32 v148, v70, v66, s66
    v_perm_b32 v152, v71, v67, s65
    v_perm_b32 v156, v71, v67, s66
    v_perm_b32 v129, v76, v72, s65
    v_perm_b32 v133, v76, v72, s66
    v_perm_b32 v137, v77, v73, s65
    v_perm_b32 v141, v77, v73, s66
    v_perm_b32 v145, v78, v74, s65
    v_perm_b32 v149, v78, v74, s66
    v_perm_b32 v153, v79, v75, s65
    v_perm_b32 v157, v79, v75, s66
    v_perm_b32 v130, v84, v80, s65
    v_perm_b32 v134, v84, v80, s66
    v_perm_b32 v138, v85, v81, s65
    v_perm_b32 v142, v85, v81, s66
    v_perm_b32 v146, v86, v82, s65
    v_perm_b32 v150, v86, v82, s66
    v_perm_b32 v154, v87, v83, s65
    v_perm_b32 v158, v87, v83, s66
    v_perm_b32 v131, v92, v88, s65
    v_perm_b32 v135, v92, v88, s66
    v_perm_b32 v139, v93, v89, s65
    v_perm_b32 v143, v93, v89, s66
    v_perm_b32 v147, v94, v90, s65
    v_perm_b32 v151, v94, v90, s66
    v_perm_b32 v155, v95, v91, s65
    v_perm_b32 v159, v95, v91, s66
    v_mfma_f32_16x16x32_bf16 a[80:83], v[128:131], v[208:211], 0
    v_mfma_f32_16x16x32_bf16 a[84:87], v[132:135], v[208:211], 0
    v_mfma_f32_16x16x32_bf16 a[88:91], v[136:139], v[208:211], 0
    v_mfma_f32_16x16x32_bf16 a[92:95], v[140:143], v[208:211], 0
    v_mfma_f32_16x16x32_bf16 a[96:99], v[144:147], v[208:211], 0
    v_mfma_f32_16x16x32_bf16 a[100:103], v[148:151], v[208:211], 0
    v_mfma_f32_16x16x32_bf16 a[104:107], v[152:155], v[208:211], 0
    v_mfma_f32_16x16x32_bf16 a[108:111], v[156:159], v[208:211], 0
    s_waitcnt vmcnt(7)
    v_perm_b32 v128, v100, v96, s65
    v_perm_b32 v132, v100, v96, s66
    v_perm_b32 v136, v101, v97, s65
    v_perm_b32 v140, v101, v97, s66
    v_perm_b32 v144, v102, v98, s65
    v_perm_b32 v148, v102, v98, s66
    v_perm_b32 v152, v103, v99, s65
    v_perm_b32 v156, v103, v99, s66
    s_waitcnt vmcnt(5)
    v_perm_b32 v129, v108, v104, s65
    v_perm_b32 v133, v108, v104, s66
    v_perm_b32 v137, v109, v105, s65
    v_perm_b32 v141, v109, v105, s66
    v_perm_b32 v145, v110, v106, s65
    v_perm_b32 v149, v110, v106, s66
    v_perm_b32 v153, v111, v107, s65
    v_perm_b32 v157, v111, v107, s66
    s_waitcnt vmcnt(3)
    v_perm_b32 v130, v116, v112, s65
    v_perm_b32 v134, v116, v112, s66
    v_perm_b32 v138, v117, v113, s65
    v_perm_b32 v142, v117, v113, s66
    v_perm_b32 v146, v118, v114, s65
    v_perm_b32 v150, v118, v114, s66
    v_perm_b32 v154, v119, v115, s65
    v_perm_b32 v158, v119, v115, s66
    s_waitcnt vmcnt(1)
    v_perm_b32 v131, v124, v120, s65
    v_perm_b32 v135, v124, v120, s66
    v_perm_b32 v139, v125, v121, s65
    v_perm_b32 v143, v125, v121, s66
    v_perm_b32 v147, v126, v122, s65
    v_perm_b32 v151, v126, v122, s66
    v_perm_b32 v155, v127, v123, s65
    v_perm_b32 v159, v127, v123, s66
    v_mfma_f32_16x16x32_bf16 a[80:83], v[128:131], v[212:215], a[80:83]
    v_mfma_f32_16x16x32_bf16 a[84:87], v[132:135], v[212:215], a[84:87]
    v_mfma_f32_16x16x32_bf16 a[88:91], v[136:139], v[212:215], a[88:91]
    v_mfma_f32_16x16x32_bf16 a[92:95], v[140:143], v[212:215], a[92:95]
    v_mfma_f32_16x16x32_bf16 a[96:99], v[144:147], v[212:215], a[96:99]
    v_mfma_f32_16x16x32_bf16 a[100:103], v[148:151], v[212:215], a[100:103]
    v_mfma_f32_16x16x32_bf16 a[104:107], v[152:155], v[212:215], a[104:107]
    v_mfma_f32_16x16x32_bf16 a[108:111], v[156:159], v[212:215], a[108:111]
    s_mov_b32 s68, 0x000f000f
    s_mov_b32 s69, 0x000f000f
    s_mov_b64 exec, s[68:69]
    ds_write_b128 v224, a[80:83]
    ds_write_b128 v225, a[84:87]
    ds_write_b128 v226, a[88:91]
    ds_write_b128 v227, a[92:95]
    ds_write_b128 v228, a[96:99]
    ds_write_b128 v229, a[100:103]
    ds_write_b128 v230, a[104:107]
    ds_write_b128 v231, a[108:111]
    s_mov_b64 exec, -1
    s_waitcnt lgkmcnt(0)
    s_barrier
    s_cmp_ge_u32 s32, 2
    s_cbranch_scc1 Lopskip_32
    ds_read_b128 v[192:195], v232 offset:8192
    ds_read_b128 v[196:199], v232 offset:10240
    ds_read_b128 v[200:203], v232 offset:12288
    ds_read_b128 v[204:207], v232 offset:14336
    s_waitcnt lgkmcnt(0)
    v_add_f32 v192, v192, v196
    v_add_f32 v200, v200, v204
    v_add_f32 v193, v193, v197
    v_add_f32 v201, v201, v205
    v_add_f32 v194, v194, v198
    v_add_f32 v202, v202, v206
    v_add_f32 v195, v195, v199
    v_add_f32 v203, v203, v207
    v_add_f32 v192, v192, v200
    v_add_f32 v193, v193, v201
    v_add_f32 v194, v194, v202
    v_add_f32 v195, v195, v203
    v_bfi_b32 v196, v23, s36, v192
    v_bfi_b32 v197, v23, s37, v193
    v_bfi_b32 v198, v23, s38, v194
    v_bfi_b32 v199, v23, s39, v195
    s_cmp_eq_u32 s61, 0
    s_cbranch_scc1 Lg_33
    global_store_dwordx4 v233, v[196:199], s[26:27]
    s_branch Le_34
Lg_33:
    global_store_dwordx4 v233, v[196:199], s[26:27] sc1
Le_34:
Lopskip_32:
    s_branch Lfin
Lfin:
Lexit:
    s_endpgm
Lcode_end:
.section .rodata,"a"
.p2align 6
.amdhsa_kernel sequential_preLN__sliding_block_cached__swiglu_ffn__decode_kernel
  .amdhsa_next_free_vgpr 368
  .amdhsa_next_free_sgpr 102
  .amdhsa_accum_offset 256
  .amdhsa_group_segment_fixed_size 0
  .amdhsa_kernarg_size 96
  .amdhsa_user_sgpr_count 2
  .amdhsa_user_sgpr_kernarg_segment_ptr 1
  .amdhsa_system_sgpr_workgroup_id_x 1
  .amdhsa_float_denorm_mode_32 3
.end_amdhsa_kernel
```
